```python
import torch

def _softmax(x, axis=-1):
    return torch.softmax(x, dim=axis)
def _gelu(x):
    return torch.nn.functional.gelu(x, approximate="tanh")
def _silu(x):
    return torch.nn.functional.silu(x)
def _sigmoid(x):
    return torch.sigmoid(x)
def _layernorm(x, axis=-1, eps=1e-5):
    m = x.mean(dim=axis, keepdim=True)
    v = x.var(dim=axis, keepdim=True, unbiased=False)
    return (x - m) / torch.sqrt(v + eps)
def _scatter_add(tgt, idx, src, axis=0):
    return tgt.clone().index_add_(axis, idx, src)
def _segment_sum(src, seg, n):
    out = torch.zeros((n,) + src.shape[1:], dtype=src.dtype)
    return out.index_add_(0, seg, src)
def _pad(x, pw):
    flat = tuple(v for pair in reversed(pw) for v in pair)
    return torch.nn.functional.pad(x, flat)

kernel_name = 'recurrent_scan__softmax_full_mha__glu_gated_swiglu__prompt'

def setup_inputs():

    _w = (lambda a: (lambda t: t.to(torch.bfloat16) if t.is_floating_point() else t)(torch.as_tensor(a)))
    def _A_setup():
        B, S, D = 1, 2048, 448
        return {
            "x": _w((lambda *s: torch.randn(*s, dtype=torch.bfloat16) * 0.05)(B, S, D)),
            "wqkv": _w((lambda *s: torch.randn(*s, dtype=torch.bfloat16) * 0.2)(D, 3 * D)),
            "wo": _w((lambda *s: torch.randn(*s, dtype=torch.bfloat16) * 0.2)(D, D)),
        }
    _A_in = _A_setup()

    def _B_setup():
        B, S, D, F = 1, 2048, 448, 1792
        return {
            "x": _w((lambda *s: torch.randn(*s, dtype=torch.bfloat16) * 0.05)(B, S, D)),
            "w1": _w((lambda *s: torch.randn(*s, dtype=torch.bfloat16) * 0.1)(D, F) * (2.0 / D) ** 0.5),
            "w3": _w((lambda *s: torch.randn(*s, dtype=torch.bfloat16) * 0.1)(D, F) * (2.0 / D) ** 0.5),
            "w2": _w((lambda *s: torch.randn(*s, dtype=torch.bfloat16) * 0.1)(F, D) * (2.0 / F) ** 0.5),
        }
    _B_in = _B_setup()

    return {
        "A_x": _A_in["x"],
        "A_wqkv": _A_in["wqkv"],
        "A_wo": _A_in["wo"],
        "B_x": _B_in["x"],
        "B_w1": _B_in["w1"],
        "B_w3": _B_in["w3"],
        "B_w2": _B_in["w2"],
    }

def reference(A_x, A_wqkv, A_wo, B_x, B_w1, B_w3, B_w2):
    def _A_ref(x, wqkv, wo):
        B, S, D = x.shape
        H = 16; Dh = D // H
        qkv = (lambda x, *d: x.permute(*d))((x @ wqkv).reshape(B, S, 3, H, Dh), 2, 0, 3, 1, 4)
        q, k, v = qkv[0], qkv[1], qkv[2]
        scale = Dh ** -0.5
        scores = torch.einsum("bhqd,bhkd->bhqk", q, k) * scale
        p = _softmax(scores, axis=-1)
        o = torch.einsum("bhqk,bhkd->bhqd", p, v)
        return (lambda x, *d: x.permute(*d))(o, 0, 2, 1, 3).reshape(B, S, D) @ wo

    def _B_ref(x, w1, w3, w2):
        gate = torch.einsum("bsd,df->bsf", x, w1)
        up = torch.einsum("bsd,df->bsf", x, w3)
        h = _silu(gate) * up
        out = torch.einsum("bsf,fd->bsd", h, w2)
        return out

    x = A_x
    xn = _layernorm(x, axis=-1)
    s = _A_ref(xn, A_wqkv, A_wo)
    g = _silu(_B_ref(xn, B_w1, B_w3, B_w2))
    return x + s * g
```

```asm
; @launch grid=(256,1,1) block=(512,1,1) lds=163840
.amdgcn_target "amdgcn-amd-amdhsa--gfx950"
.text
.globl recurrent_scan__softmax_full_mha__glu_gated_swiglu__prompt_kernel
.p2align 8
.type recurrent_scan__softmax_full_mha__glu_gated_swiglu__prompt_kernel,@function
recurrent_scan__softmax_full_mha__glu_gated_swiglu__prompt_kernel:
    s_cmp_ge_u32 s2, 256
    s_cbranch_scc1 L_end
    s_load_dwordx16 s[4:19], s[0:1], 0
    s_load_dwordx4 s[20:23], s[0:1], 64
    v_lshrrev_b32 v22, 6, v0
    v_and_b32 v1, 63, v0
    v_readfirstlane_b32 s48, v22
    s_and_b32 s68, s2, 1
    s_bfe_u32 s69, s2, 0x30003
    s_lshl3_add_u32 s51, s68, s69
    s_bfe_u32 s68, s2, 0x20001
    s_lshr_b32 s69, s2, 6
    s_lshl2_add_u32 s56, s68, s69
    s_lshl2_add_u32 s52, s69, s68
    v_bfe_u32 v22, v0, 3, 3
    v_and_b32 v23, 7, v0
    s_lshl_b32 s68, s69, 2
    s_and_b32 s71, s68, 4
    s_xor_b32 s71, s71, s48
    s_and_b32 s64, s68, 8
    s_lshl3_add_u32 s68, s51, s71
    s_lshl4_add_u32 s69, s68, s64
    s_xor_b32 s68, s69, 8
    s_mulk_i32 s69, 896
    s_mulk_i32 s68, 896
    v_mul_u32_u24 v24, 896, v22
    v_lshl_add_u32 v24, v23, 4, v24
    s_mov_b32 s26, 0x1c0000
    s_mov_b32 s27, 0x20000
    s_cmp_ge_u32 s48, 4
    s_waitcnt lgkmcnt(0)
    s_mov_b64 s[24:25], s[4:5]
    s_load_dword s66, s[6:7], 0
    s_load_dword s66, s[12:13], 0
    s_load_dword s66, s[14:15], 0
    s_cbranch_scc1 L_x0
    buffer_load_dwordx4 v[128:131], v24, s[24:27], s69 offen offset:0
    buffer_load_dwordx4 v[132:135], v24, s[24:27], s69 offen offset:128
    buffer_load_dwordx4 v[136:139], v24, s[24:27], s69 offen offset:256
    buffer_load_dwordx4 v[140:143], v24, s[24:27], s69 offen offset:384
    buffer_load_dwordx4 v[144:147], v24, s[24:27], s69 offen offset:512
    buffer_load_dwordx4 v[148:151], v24, s[24:27], s69 offen offset:640
    buffer_load_dwordx4 v[152:155], v24, s[24:27], s69 offen offset:768
    buffer_load_dwordx4 v[156:159], v24, s[24:27], s68 offen offset:0
    buffer_load_dwordx4 v[160:163], v24, s[24:27], s68 offen offset:128
    buffer_load_dwordx4 v[164:167], v24, s[24:27], s68 offen offset:256
    s_branch L_x1
L_x0:
    s_getpc_b64 s[74:75]
L_pc:
    s_add_u32 s74, s74, recurrent_scan__softmax_full_mha__glu_gated_swiglu__prompt_kernel-L_pc
    s_addc_u32 s75, s75, -1
    s_lshr_b32 s3, s2, 3
    s_lshl_b32 s3, s3, 7
    v_and_b32 v20, 255, v0
    v_lshl_add_u32 v20, v20, 12, s3
    v_min_u32 v251, L_code_end-recurrent_scan__softmax_full_mha__glu_gated_swiglu__prompt_kernel-4, v20
    global_load_dword v251, v251, s[74:75]
L_x1:
    s_mov_b32 s62, s69
    s_mov_b32 s63, s68
    s_mov_b64 s[44:45], s[22:23]
    s_mov_b32 s46, 0x1200000
    s_mov_b32 s47, 0x20000
    s_and_b32 s49, s48, 3
    s_lshr_b32 s50, s48, 2
    s_lshl_b32 s59, s48, 10
    s_lshl_b32 s72, s50, 1
    s_cmp_ge_u32 s52, 12
    s_cbranch_scc1 L_r0f
    s_mov_b64 s[36:37], s[6:7]
    s_mov_b32 s38, 0x126000
    s_mov_b32 s39, 0x20000
    s_mov_b64 s[40:41], s[6:7]
    s_and_b32 s69, s52, 3
    s_mul_i32 s54, s52, 224
    s_cmp_eq_u32 s69, 3
    s_cselect_b32 s70, 32, 0
    s_sub_u32 s54, s54, s70
    s_add_u32 s55, s54, 128
    s_mul_i32 s60, s50, 112
    s_add_u32 s60, s60, s70
    s_add_u32 s61, s60, 56
    s_movk_i32 s58, 2688
    s_branch L_r0j
L_r0f:
    s_mov_b64 s[36:37], s[12:13]
    s_mov_b32 s38, 0x188000
    s_mov_b32 s39, 0x20000
    s_mov_b64 s[40:41], s[14:15]
    s_add_u32 s68, s52, 12
    s_lshl_b32 s54, s68, 7
    s_mov_b32 s55, s54
    s_lshl_b32 s60, s50, 6
    s_add_u32 s61, s60, 128
    s_movk_i32 s58, 3584
L_r0j:
    s_mov_b32 s42, s38
    s_mov_b32 s43, 0x20000
    s_and_b32 s70, s51, 7
    s_cmp_ge_u32 s48, 4
    s_cselect_b32 s68, 448, 0
    s_cselect_b32 s69, 0, 112
    s_mul_i32 s67, s49, s69
    s_add_u32 s68, s68, s67
    s_add_u32 s68, s68, s70
    s_lshr_b32 s69, s69, 3
    s_sub_u32 s69, s69, 1
    v_min_u32 v33, s69, v1
    v_lshl_add_u32 v33, v33, 3, s68
    v_mul_lo_u32 v33, v33, s58
    s_cmp_ge_u32 s48, 4
    s_cbranch_scc1 L_w0
    buffer_load_dword v252, v33, s[36:39], s54 offen
    buffer_load_dword v252, v33, s[40:43], s55 offen
L_w0:
    v_lshrrev_b32 v25, 2, v1
    v_and_b32 v25, 4, v25
    v_xor_b32 v25, v25, v23
    v_lshl_add_u32 v26, s48, 3, v22
    v_mul_lo_u32 v3, v26, s58
    v_lshl_add_u32 v3, v25, 4, v3
    v_mul_u32_u24 v4, 3584, v26
    v_lshl_add_u32 v4, v25, 4, v4
    s_lshl_b32 s68, s58, 5
    v_subrev_u32 v32, s68, v3
    v_lshrrev_b32 v26, 5, v1
    v_bfe_u32 v27, v1, 2, 2
    v_lshl_add_u32 v27, v26, 3, v27
    v_lshlrev_b32 v248, 7, v27
    v_and_b32 v28, 8, v1
    v_lshlrev_b32 v249, 3, v28
    v_and_b32 v29, 3, v1
    v_and_b32 v30, 16, v1
    v_lshlrev_b32 v30, 1, v30
    v_lshl_add_u32 v239, v29, 3, v30
    v_add_u32 v30, s60, v239
    v_and_b32 v31, 127, v30
    v_xor_b32 v31, v31, v249
    v_and_b32 v30, 128, v30
    v_lshl_add_u32 v30, v30, 6, v31
    v_add_u32 v5, v30, v248
    v_add_u32 v30, s61, v239
    v_and_b32 v31, 127, v30
    v_xor_b32 v31, v31, v249
    v_and_b32 v30, 128, v30
    v_lshl_add_u32 v30, v30, 6, v31
    v_add_u32 v6, v30, v248
    s_and_b32 s68, s71, 1
    s_lshl4_add_u32 s68, s68, s64
    v_add_u32 v30, s68, v22
    v_xor_b32 v30, v30, v23
    v_lshlrev_b32 v30, 4, v30
    v_lshrrev_b32 v31, 1, v23
    v_lshl_add_u32 v30, v31, 12, v30
    v_and_b32 v31, 1, v23
    v_lshl_add_u32 v30, v31, 9, v30
    s_lshr_b32 s68, s71, 1
    v_lshl_add_u32 v240, s68, 10, v30
    v_add_u32 v241, 0x10000, v240
    v_and_b32 v30, 31, v1
    v_xor_b32 v30, v30, v26
    v_lshlrev_b32 v30, 4, v30
    v_lshl_add_u32 v30, v26, 9, v30
    v_lshl_add_u32 v12, s49, 10, v30
    v_xor_b32 v13, 4128, v12
    v_xor_b32 v14, 8256, v12
    v_xor_b32 v15, 12384, v12
    s_lshl4_add_u32 s68, s71, s64
    v_add_lshl_u32 v242, v22, s68, 2
    s_mul_i32 s69, s49, 112
    s_add_u32 s68, s70, s69
    v_min_u32 v30, 13, v1
    v_lshl_add_u32 v30, v30, 3, s68
    v_mul_u32_u24 v254, 3584, v30
    s_lshl_b32 s58, s58, 6
    s_mov_b64 s[28:29], s[12:13]
    s_mov_b32 s30, 0x188000
    s_mov_b32 s31, 0x20000
    s_mov_b64 s[32:33], s[14:15]
    s_mov_b32 s34, 0x188000
    s_mov_b32 s35, 0x20000
    s_lshr_b32 s68, s56, 1
    s_lshl_b32 s56, s56, 7
    s_add_u32 s68, s68, 16
    s_lshl_b32 s57, s68, 7
    s_cmp_lt_u32 s48, 4
    s_cbranch_scc1 L_x2
    buffer_load_dwordx4 v[128:131], v24, s[24:27], s62 offen offset:0
    buffer_load_dwordx4 v[132:135], v24, s[24:27], s62 offen offset:128
    buffer_load_dwordx4 v[136:139], v24, s[24:27], s62 offen offset:256
    buffer_load_dwordx4 v[140:143], v24, s[24:27], s62 offen offset:384
    buffer_load_dwordx4 v[144:147], v24, s[24:27], s62 offen offset:512
    buffer_load_dwordx4 v[148:151], v24, s[24:27], s62 offen offset:640
    buffer_load_dwordx4 v[152:155], v24, s[24:27], s62 offen offset:768
    buffer_load_dwordx4 v[156:159], v24, s[24:27], s63 offen offset:0
    buffer_load_dwordx4 v[160:163], v24, s[24:27], s63 offen offset:128
    buffer_load_dwordx4 v[164:167], v24, s[24:27], s63 offen offset:256
L_x2:
    buffer_load_dwordx4 v[168:171], v24, s[24:27], s63 offen offset:384
    buffer_load_dwordx4 v[172:175], v24, s[24:27], s63 offen offset:512
    buffer_load_dwordx4 v[176:179], v24, s[24:27], s63 offen offset:640
    buffer_load_dwordx4 v[180:183], v24, s[24:27], s63 offen offset:768
    s_lshl_b32 s71, s2, 9
    s_add_u32 s71, s71, 17825792
    s_mov_b32 s62, 0x3f803f80
    s_movk_i32 s63, 0x3f80
    s_mov_b32 s64, 1.0
    v_mov_b32 v224, 0
    v_mov_b32 v225, 0
    v_mov_b32 v226, 0
    v_mov_b32 v227, 0
    v_mov_b32 v228, 0
    v_mov_b32 v229, 0
    v_mov_b32 v230, 0
    v_mov_b32 v231, 0
    s_cmp_lt_u32 s48, 4
    s_cbranch_scc1 L_lnA
    s_waitcnt vmcnt(0)
    s_mov_b32 s60, s54
    s_mov_b32 s61, s55
    s_add_u32 m0, s59, 114688
    s_nop 0
    buffer_load_dwordx4 v3, s[36:39], s60 offen lds
    s_add_u32 m0, s59, 122880
    s_nop 0
    buffer_load_dwordx4 v3, s[40:43], s61 offen lds
    s_add_u32 m0, s59, 110592
    s_nop 0
    buffer_load_dwordx4 v32, s[36:39], s60 offen lds
    s_add_u32 m0, s59, 118784
    s_nop 0
    buffer_load_dwordx4 v32, s[40:43], s61 offen lds
    s_add_u32 m0, s59, 131072
    s_add_u32 s60, s60, s58
    buffer_load_dwordx4 v3, s[36:39], s60 offen lds
    s_add_u32 m0, s59, 139264
    s_add_u32 s61, s61, s58
    buffer_load_dwordx4 v3, s[40:43], s61 offen lds
    s_add_u32 m0, s59, 126976
    s_nop 0
    buffer_load_dwordx4 v32, s[36:39], s60 offen lds
    s_add_u32 m0, s59, 135168
    s_nop 0
    buffer_load_dwordx4 v32, s[40:43], s61 offen lds
    s_branch L_lnB
L_lnA:
    s_lshl1_add_u32 s60, s58, s54
    s_lshl1_add_u32 s61, s58, s55
    s_waitcnt vmcnt(0)
L_lnB:
    v_dot2c_f32_bf16 v224, s62, v128
    v_dot2c_f32_bf16 v228, s62, v156
    v_dot2c_f32_bf16 v225, s62, v129
    v_dot2c_f32_bf16 v229, s62, v157
    v_dot2c_f32_bf16 v226, s62, v130
    v_dot2c_f32_bf16 v230, s62, v158
    v_dot2c_f32_bf16 v227, s62, v131
    v_dot2c_f32_bf16 v231, s62, v159
    v_dot2c_f32_bf16 v224, s62, v132
    v_dot2c_f32_bf16 v228, s62, v160
    v_dot2c_f32_bf16 v225, s62, v133
    v_dot2c_f32_bf16 v229, s62, v161
    v_dot2c_f32_bf16 v226, s62, v134
    v_dot2c_f32_bf16 v230, s62, v162
    v_dot2c_f32_bf16 v227, s62, v135
    v_dot2c_f32_bf16 v231, s62, v163
    v_dot2c_f32_bf16 v224, s62, v136
    v_dot2c_f32_bf16 v228, s62, v164
    v_dot2c_f32_bf16 v225, s62, v137
    v_dot2c_f32_bf16 v229, s62, v165
    v_dot2c_f32_bf16 v226, s62, v138
    v_dot2c_f32_bf16 v230, s62, v166
    v_dot2c_f32_bf16 v227, s62, v139
    v_dot2c_f32_bf16 v231, s62, v167
    v_dot2c_f32_bf16 v224, s62, v140
    v_dot2c_f32_bf16 v228, s62, v168
    v_dot2c_f32_bf16 v225, s62, v141
    v_dot2c_f32_bf16 v229, s62, v169
    v_dot2c_f32_bf16 v226, s62, v142
    v_dot2c_f32_bf16 v230, s62, v170
    v_dot2c_f32_bf16 v227, s62, v143
    v_dot2c_f32_bf16 v231, s62, v171
    v_dot2c_f32_bf16 v224, s62, v144
    v_dot2c_f32_bf16 v228, s62, v172
    v_dot2c_f32_bf16 v225, s62, v145
    v_dot2c_f32_bf16 v229, s62, v173
    v_dot2c_f32_bf16 v226, s62, v146
    v_dot2c_f32_bf16 v230, s62, v174
    v_dot2c_f32_bf16 v227, s62, v147
    v_dot2c_f32_bf16 v231, s62, v175
    v_dot2c_f32_bf16 v224, s62, v148
    v_dot2c_f32_bf16 v228, s62, v176
    v_dot2c_f32_bf16 v225, s62, v149
    v_dot2c_f32_bf16 v229, s62, v177
    v_dot2c_f32_bf16 v226, s62, v150
    v_dot2c_f32_bf16 v230, s62, v178
    v_dot2c_f32_bf16 v227, s62, v151
    v_dot2c_f32_bf16 v231, s62, v179
    v_dot2c_f32_bf16 v224, s62, v152
    v_dot2c_f32_bf16 v228, s62, v180
    v_dot2c_f32_bf16 v225, s62, v153
    v_dot2c_f32_bf16 v229, s62, v181
    v_dot2c_f32_bf16 v226, s62, v154
    v_dot2c_f32_bf16 v230, s62, v182
    v_dot2c_f32_bf16 v227, s62, v155
    v_dot2c_f32_bf16 v231, s62, v183
    v_add_f32 v224, v224, v225
    v_add_f32 v228, v228, v229
    v_add_f32 v226, v226, v227
    v_add_f32 v230, v230, v231
    v_add_f32 v244, v224, v226
    v_add_f32 v245, v228, v230
    s_nop 0
    v_add_f32_dpp v244, v244, v244 quad_perm:[1,0,3,2] row_mask:0xf bank_mask:0xf
    v_add_f32_dpp v245, v245, v245 quad_perm:[1,0,3,2] row_mask:0xf bank_mask:0xf
    s_nop 0
    v_add_f32_dpp v244, v244, v244 quad_perm:[2,3,0,1] row_mask:0xf bank_mask:0xf
    v_add_f32_dpp v245, v245, v245 quad_perm:[2,3,0,1] row_mask:0xf bank_mask:0xf
    s_nop 0
    v_add_f32_dpp v244, v244, v244 row_half_mirror row_mask:0xf bank_mask:0xf
    v_add_f32_dpp v245, v245, v245 row_half_mirror row_mask:0xf bank_mask:0xf
    v_mov_b32 v224, 0
    v_mov_b32 v225, 0
    v_mov_b32 v226, 0
    v_mov_b32 v227, 0
    v_mov_b32 v228, 0
    v_mov_b32 v229, 0
    v_mov_b32 v230, 0
    v_mov_b32 v231, 0
    v_mul_f32 v244, 0xbb124925, v244
    v_mul_f32 v245, 0xbb124925, v245
    s_cmp_lt_u32 s48, 4
    s_cbranch_scc1 L_c2
    s_add_u32 m0, s59, 147456
    s_add_u32 s60, s60, s58
    buffer_load_dwordx4 v3, s[36:39], s60 offen lds
    s_add_u32 m0, s59, 155648
    s_add_u32 s61, s61, s58
    buffer_load_dwordx4 v3, s[40:43], s61 offen lds
    s_add_u32 m0, s59, 143360
    s_nop 0
    buffer_load_dwordx4 v32, s[36:39], s60 offen lds
    s_add_u32 m0, s59, 151552
    s_nop 0
    buffer_load_dwordx4 v32, s[40:43], s61 offen lds
L_c2:
    v_dot2_f32_bf16 v216, v128, s63, v244
    v_dot2_f32_bf16 v217, v128, s64, v244
    v_dot2_f32_bf16 v218, v129, s63, v244
    v_dot2_f32_bf16 v219, v129, s64, v244
    v_dot2_f32_bf16 v220, v130, s63, v244
    v_dot2_f32_bf16 v221, v130, s64, v244
    v_dot2_f32_bf16 v222, v131, s63, v244
    v_dot2_f32_bf16 v223, v131, s64, v244
    v_cvt_pk_bf16_f32 v128, v216, v217
    v_cvt_pk_bf16_f32 v129, v218, v219
    v_cvt_pk_bf16_f32 v130, v220, v221
    v_cvt_pk_bf16_f32 v131, v222, v223
    v_dot2_f32_bf16 v216, v132, s63, v244
    v_dot2_f32_bf16 v217, v132, s64, v244
    v_dot2_f32_bf16 v218, v133, s63, v244
    v_dot2_f32_bf16 v219, v133, s64, v244
    v_dot2_f32_bf16 v220, v134, s63, v244
    v_dot2_f32_bf16 v221, v134, s64, v244
    v_dot2_f32_bf16 v222, v135, s63, v244
    v_dot2_f32_bf16 v223, v135, s64, v244
    ds_write_b128 v240, v[128:131] offset:0
    v_cvt_pk_bf16_f32 v132, v216, v217
    v_cvt_pk_bf16_f32 v133, v218, v219
    v_cvt_pk_bf16_f32 v134, v220, v221
    v_cvt_pk_bf16_f32 v135, v222, v223
    v_dot2_f32_bf16 v216, v136, s63, v244
    v_dot2_f32_bf16 v217, v136, s64, v244
    v_dot2_f32_bf16 v218, v137, s63, v244
    v_dot2_f32_bf16 v219, v137, s64, v244
    v_dot2_f32_bf16 v220, v138, s63, v244
    v_dot2_f32_bf16 v221, v138, s64, v244
    v_dot2_f32_bf16 v222, v139, s63, v244
    v_dot2_f32_bf16 v223, v139, s64, v244
    ds_write_b128 v240, v[132:135] offset:16384
    v_cvt_pk_bf16_f32 v136, v216, v217
    v_cvt_pk_bf16_f32 v137, v218, v219
    v_cvt_pk_bf16_f32 v138, v220, v221
    v_cvt_pk_bf16_f32 v139, v222, v223
    v_dot2_f32_bf16 v216, v140, s63, v244
    v_dot2_f32_bf16 v217, v140, s64, v244
    v_dot2_f32_bf16 v218, v141, s63, v244
    v_dot2_f32_bf16 v219, v141, s64, v244
    v_dot2_f32_bf16 v220, v142, s63, v244
    v_dot2_f32_bf16 v221, v142, s64, v244
    v_dot2_f32_bf16 v222, v143, s63, v244
    v_dot2_f32_bf16 v223, v143, s64, v244
    ds_write_b128 v240, v[136:139] offset:32768
    v_cvt_pk_bf16_f32 v140, v216, v217
    v_cvt_pk_bf16_f32 v141, v218, v219
    v_cvt_pk_bf16_f32 v142, v220, v221
    v_cvt_pk_bf16_f32 v143, v222, v223
    v_dot2_f32_bf16 v216, v144, s63, v244
    v_dot2_f32_bf16 v217, v144, s64, v244
    v_dot2_f32_bf16 v218, v145, s63, v244
    v_dot2_f32_bf16 v219, v145, s64, v244
    v_dot2_f32_bf16 v220, v146, s63, v244
    v_dot2_f32_bf16 v221, v146, s64, v244
    v_dot2_f32_bf16 v222, v147, s63, v244
    v_dot2_f32_bf16 v223, v147, s64, v244
    ds_write_b128 v240, v[140:143] offset:49152
    v_cvt_pk_bf16_f32 v144, v216, v217
    v_cvt_pk_bf16_f32 v145, v218, v219
    v_cvt_pk_bf16_f32 v146, v220, v221
    v_cvt_pk_bf16_f32 v147, v222, v223
    v_dot2_f32_bf16 v216, v148, s63, v244
    v_dot2_f32_bf16 v217, v148, s64, v244
    v_dot2_f32_bf16 v218, v149, s63, v244
    v_dot2_f32_bf16 v219, v149, s64, v244
    v_dot2_f32_bf16 v220, v150, s63, v244
    v_dot2_f32_bf16 v221, v150, s64, v244
    v_dot2_f32_bf16 v222, v151, s63, v244
    v_dot2_f32_bf16 v223, v151, s64, v244
    ds_write_b128 v241, v[144:147] offset:0
    v_cvt_pk_bf16_f32 v148, v216, v217
    v_cvt_pk_bf16_f32 v149, v218, v219
    v_cvt_pk_bf16_f32 v150, v220, v221
    v_cvt_pk_bf16_f32 v151, v222, v223
    v_dot2_f32_bf16 v216, v152, s63, v244
    v_dot2_f32_bf16 v217, v152, s64, v244
    v_dot2_f32_bf16 v218, v153, s63, v244
    v_dot2_f32_bf16 v219, v153, s64, v244
    v_dot2_f32_bf16 v220, v154, s63, v244
    v_dot2_f32_bf16 v221, v154, s64, v244
    v_dot2_f32_bf16 v222, v155, s63, v244
    v_dot2_f32_bf16 v223, v155, s64, v244
    ds_write_b128 v241, v[148:151] offset:16384
    v_cvt_pk_bf16_f32 v152, v216, v217
    v_cvt_pk_bf16_f32 v153, v218, v219
    v_cvt_pk_bf16_f32 v154, v220, v221
    v_cvt_pk_bf16_f32 v155, v222, v223
    v_dot2_f32_bf16 v216, v156, s63, v245
    v_dot2_f32_bf16 v217, v156, s64, v245
    v_dot2_f32_bf16 v218, v157, s63, v245
    v_dot2_f32_bf16 v219, v157, s64, v245
    v_dot2_f32_bf16 v220, v158, s63, v245
    v_dot2_f32_bf16 v221, v158, s64, v245
    v_dot2_f32_bf16 v222, v159, s63, v245
    v_dot2_f32_bf16 v223, v159, s64, v245
    ds_write_b128 v241, v[152:155] offset:32768
    v_xor_b32 v240, 128, v240
    v_xor_b32 v241, 128, v241
    v_cvt_pk_bf16_f32 v156, v216, v217
    v_cvt_pk_bf16_f32 v157, v218, v219
    v_cvt_pk_bf16_f32 v158, v220, v221
    v_cvt_pk_bf16_f32 v159, v222, v223
    v_dot2_f32_bf16 v216, v160, s63, v245
    v_dot2_f32_bf16 v217, v160, s64, v245
    v_dot2_f32_bf16 v218, v161, s63, v245
    v_dot2_f32_bf16 v219, v161, s64, v245
    v_dot2_f32_bf16 v220, v162, s63, v245
    v_dot2_f32_bf16 v221, v162, s64, v245
    v_dot2_f32_bf16 v222, v163, s63, v245
    v_dot2_f32_bf16 v223, v163, s64, v245
    ds_write_b128 v240, v[156:159] offset:0
    v_cvt_pk_bf16_f32 v160, v216, v217
    v_cvt_pk_bf16_f32 v161, v218, v219
    v_cvt_pk_bf16_f32 v162, v220, v221
    v_cvt_pk_bf16_f32 v163, v222, v223
    v_dot2_f32_bf16 v216, v164, s63, v245
    v_dot2_f32_bf16 v217, v164, s64, v245
    v_dot2_f32_bf16 v218, v165, s63, v245
    v_dot2_f32_bf16 v219, v165, s64, v245
    v_dot2_f32_bf16 v220, v166, s63, v245
    v_dot2_f32_bf16 v221, v166, s64, v245
    v_dot2_f32_bf16 v222, v167, s63, v245
    v_dot2_f32_bf16 v223, v167, s64, v245
    ds_write_b128 v240, v[160:163] offset:16384
    v_cvt_pk_bf16_f32 v164, v216, v217
    v_cvt_pk_bf16_f32 v165, v218, v219
    v_cvt_pk_bf16_f32 v166, v220, v221
    v_cvt_pk_bf16_f32 v167, v222, v223
    v_dot2_f32_bf16 v216, v168, s63, v245
    v_dot2_f32_bf16 v217, v168, s64, v245
    v_dot2_f32_bf16 v218, v169, s63, v245
    v_dot2_f32_bf16 v219, v169, s64, v245
    v_dot2_f32_bf16 v220, v170, s63, v245
    v_dot2_f32_bf16 v221, v170, s64, v245
    v_dot2_f32_bf16 v222, v171, s63, v245
    v_dot2_f32_bf16 v223, v171, s64, v245
    ds_write_b128 v240, v[164:167] offset:32768
    v_cvt_pk_bf16_f32 v168, v216, v217
    v_cvt_pk_bf16_f32 v169, v218, v219
    v_cvt_pk_bf16_f32 v170, v220, v221
    v_cvt_pk_bf16_f32 v171, v222, v223
    v_dot2_f32_bf16 v216, v172, s63, v245
    v_dot2_f32_bf16 v217, v172, s64, v245
    v_dot2_f32_bf16 v218, v173, s63, v245
    v_dot2_f32_bf16 v219, v173, s64, v245
    v_dot2_f32_bf16 v220, v174, s63, v245
    v_dot2_f32_bf16 v221, v174, s64, v245
    v_dot2_f32_bf16 v222, v175, s63, v245
    v_dot2_f32_bf16 v223, v175, s64, v245
    ds_write_b128 v240, v[168:171] offset:49152
    v_cvt_pk_bf16_f32 v172, v216, v217
    v_cvt_pk_bf16_f32 v173, v218, v219
    v_cvt_pk_bf16_f32 v174, v220, v221
    v_cvt_pk_bf16_f32 v175, v222, v223
    v_dot2_f32_bf16 v216, v176, s63, v245
    v_dot2_f32_bf16 v217, v176, s64, v245
    v_dot2_f32_bf16 v218, v177, s63, v245
    v_dot2_f32_bf16 v219, v177, s64, v245
    v_dot2_f32_bf16 v220, v178, s63, v245
    v_dot2_f32_bf16 v221, v178, s64, v245
    v_dot2_f32_bf16 v222, v179, s63, v245
    v_dot2_f32_bf16 v223, v179, s64, v245
    ds_write_b128 v241, v[172:175] offset:0
    v_cvt_pk_bf16_f32 v176, v216, v217
    v_cvt_pk_bf16_f32 v177, v218, v219
    v_cvt_pk_bf16_f32 v178, v220, v221
    v_cvt_pk_bf16_f32 v179, v222, v223
    v_dot2_f32_bf16 v216, v180, s63, v245
    v_dot2_f32_bf16 v217, v180, s64, v245
    v_dot2_f32_bf16 v218, v181, s63, v245
    v_dot2_f32_bf16 v219, v181, s64, v245
    v_dot2_f32_bf16 v220, v182, s63, v245
    v_dot2_f32_bf16 v221, v182, s64, v245
    v_dot2_f32_bf16 v222, v183, s63, v245
    v_dot2_f32_bf16 v223, v183, s64, v245
    ds_write_b128 v241, v[176:179] offset:16384
    v_cvt_pk_bf16_f32 v180, v216, v217
    v_cvt_pk_bf16_f32 v181, v218, v219
    v_cvt_pk_bf16_f32 v182, v220, v221
    v_cvt_pk_bf16_f32 v183, v222, v223
    ds_write_b128 v241, v[180:183] offset:32768
    v_dot2c_f32_bf16 v224, v128, v128
    v_dot2c_f32_bf16 v228, v156, v156
    v_dot2c_f32_bf16 v225, v129, v129
    v_dot2c_f32_bf16 v229, v157, v157
    v_dot2c_f32_bf16 v226, v130, v130
    v_dot2c_f32_bf16 v230, v158, v158
    v_dot2c_f32_bf16 v227, v131, v131
    v_dot2c_f32_bf16 v231, v159, v159
    v_dot2c_f32_bf16 v224, v132, v132
    v_dot2c_f32_bf16 v228, v160, v160
    v_dot2c_f32_bf16 v225, v133, v133
    v_dot2c_f32_bf16 v229, v161, v161
    v_dot2c_f32_bf16 v226, v134, v134
    v_dot2c_f32_bf16 v230, v162, v162
    v_dot2c_f32_bf16 v227, v135, v135
    v_dot2c_f32_bf16 v231, v163, v163
    v_dot2c_f32_bf16 v224, v136, v136
    v_dot2c_f32_bf16 v228, v164, v164
    v_dot2c_f32_bf16 v225, v137, v137
    v_dot2c_f32_bf16 v229, v165, v165
    v_dot2c_f32_bf16 v226, v138, v138
    v_dot2c_f32_bf16 v230, v166, v166
    v_dot2c_f32_bf16 v227, v139, v139
    v_dot2c_f32_bf16 v231, v167, v167
    v_dot2c_f32_bf16 v224, v140, v140
    v_dot2c_f32_bf16 v228, v168, v168
    v_dot2c_f32_bf16 v225, v141, v141
    v_dot2c_f32_bf16 v229, v169, v169
    v_dot2c_f32_bf16 v226, v142, v142
    v_dot2c_f32_bf16 v230, v170, v170
    v_dot2c_f32_bf16 v227, v143, v143
    v_dot2c_f32_bf16 v231, v171, v171
    v_dot2c_f32_bf16 v224, v144, v144
    v_dot2c_f32_bf16 v228, v172, v172
    v_dot2c_f32_bf16 v225, v145, v145
    v_dot2c_f32_bf16 v229, v173, v173
    v_dot2c_f32_bf16 v226, v146, v146
    v_dot2c_f32_bf16 v230, v174, v174
    v_dot2c_f32_bf16 v227, v147, v147
    v_dot2c_f32_bf16 v231, v175, v175
    v_dot2c_f32_bf16 v224, v148, v148
    v_dot2c_f32_bf16 v228, v176, v176
    v_dot2c_f32_bf16 v225, v149, v149
    v_dot2c_f32_bf16 v229, v177, v177
    v_dot2c_f32_bf16 v226, v150, v150
    v_dot2c_f32_bf16 v230, v178, v178
    v_dot2c_f32_bf16 v227, v151, v151
    v_dot2c_f32_bf16 v231, v179, v179
    v_dot2c_f32_bf16 v224, v152, v152
    v_dot2c_f32_bf16 v228, v180, v180
    v_dot2c_f32_bf16 v225, v153, v153
    v_dot2c_f32_bf16 v229, v181, v181
    v_dot2c_f32_bf16 v226, v154, v154
    v_dot2c_f32_bf16 v230, v182, v182
    v_dot2c_f32_bf16 v227, v155, v155
    v_dot2c_f32_bf16 v231, v183, v183
    v_mov_b32 v216, 0x3727c5ac
    v_mov_b32 v217, 0x3727c5ac
    v_xor_b32 v218, 32, v242
    v_add_f32 v224, v224, v225
    v_add_f32 v228, v228, v229
    v_add_f32 v226, v226, v227
    v_add_f32 v230, v230, v231
    v_add_f32 v244, v224, v226
    v_add_f32 v245, v228, v230
    s_nop 0
    v_add_f32_dpp v244, v244, v244 quad_perm:[1,0,3,2] row_mask:0xf bank_mask:0xf
    v_add_f32_dpp v245, v245, v245 quad_perm:[1,0,3,2] row_mask:0xf bank_mask:0xf
    s_nop 0
    v_add_f32_dpp v244, v244, v244 quad_perm:[2,3,0,1] row_mask:0xf bank_mask:0xf
    v_add_f32_dpp v245, v245, v245 quad_perm:[2,3,0,1] row_mask:0xf bank_mask:0xf
    s_nop 0
    v_add_f32_dpp v244, v244, v244 row_half_mirror row_mask:0xf bank_mask:0xf
    v_add_f32_dpp v245, v245, v245 row_half_mirror row_mask:0xf bank_mask:0xf
    v_fmac_f32 v216, 0x3b124925, v244
    v_fmac_f32 v217, 0x3b124925, v245
    s_cmp_ge_u32 s48, 4
    s_cbranch_scc1 L_lnD
    s_lshl3_add_u32 s70, s2, s48
    s_cmp_lg_u32 s70, 0
    s_cbranch_scc1 L_noinit
    v_lshlrev_b32 v25, 7, v1
    v_mov_b32 v26, 0
    s_mov_b32 s3, 18350080
    buffer_store_dword v26, v25, s[44:47], s3 offen sc1
    s_add_u32 s3, s3, 8192
    buffer_store_dword v26, v25, s[44:47], s3 offen sc1
    s_add_u32 s3, s3, 8192
    buffer_store_dword v26, v25, s[44:47], s3 offen sc1
    s_add_u32 s3, s3, 8192
    buffer_store_dword v26, v25, s[44:47], s3 offen sc1
    s_add_u32 s3, s3, 8192
    buffer_store_dword v26, v25, s[44:47], s3 offen sc1
L_noinit:
    buffer_load_dword v252, v254, s[28:31], s56 offen
    buffer_load_dword v252, v254, s[32:35], s56 offen
    buffer_load_dword v252, v254, s[28:31], s57 offen
    buffer_load_dword v252, v254, s[32:35], s57 offen
    s_lshl2_add_u32 s68, s2, s48
    s_mul_i32 s69, s68, 1664
    s_lshl_b32 s68, s68, 9
    v_min_u32 v253, 12, v1
    v_lshl_add_u32 v253, v253, 7, s69
    v_min_u32 v253, 1605628, v253
    v_min_u32 v254, 3, v1
    v_lshl_add_u32 v254, v254, 7, s68
    v_min_u32 v254, 401404, v254
    global_load_dword v252, v253, s[16:17]
    global_load_dword v252, v254, s[8:9]
    s_branch L_lnE
L_lnD:
    s_waitcnt vmcnt(4)
L_lnE:
    s_waitcnt lgkmcnt(0)
    s_barrier
    ds_read_b128 v[16:19], v12 offset:0
    ds_read_b128 v[20:23], v13 offset:0
    ds_read_b128 v[24:27], v14 offset:0
    ds_read_b128 v[28:31], v15 offset:0
    v_add_u32 v10, 0x10000, v5
    ds_read_b64_tr_b16 v[192:193], v10 offset:49152
    ds_read_b64_tr_b16 v[194:195], v10 offset:49664
    v_add_u32 v11, 0x10000, v6
    ds_read_b64_tr_b16 v[196:197], v11 offset:49152
    ds_read_b64_tr_b16 v[198:199], v11 offset:49664
    ds_read_b64_tr_b16 v[200:201], v10 offset:51200
    ds_read_b64_tr_b16 v[202:203], v10 offset:51712
    ds_read_b64_tr_b16 v[204:205], v11 offset:51200
    ds_read_b64_tr_b16 v[206:207], v11 offset:51712
    buffer_store_dword v216, v242, s[44:47], s71 offen
    buffer_store_dword v217, v218, s[44:47], s71 offen
    s_waitcnt lgkmcnt(4)
    v_mfma_f32_32x32x16_bf16 v[128:143], v[192:195], v[16:19], 0
    ds_read_b64_tr_b16 v[208:209], v10 offset:53248
    ds_read_b64_tr_b16 v[210:211], v10 offset:53760
    ds_read_b128 v[32:35], v12 offset:16384
    v_mfma_f32_32x32x16_bf16 v[144:159], v[196:199], v[16:19], 0
    ds_read_b64_tr_b16 v[212:213], v11 offset:53248
    ds_read_b64_tr_b16 v[214:215], v11 offset:53760
    ds_read_b128 v[36:39], v13 offset:16384
    s_waitcnt lgkmcnt(6)
    v_mfma_f32_32x32x16_bf16 v[128:143], v[200:203], v[20:23], v[128:143]
    ds_read_b64_tr_b16 v[192:193], v10 offset:55296
    ds_read_b64_tr_b16 v[194:195], v10 offset:55808
    ds_read_b128 v[40:43], v14 offset:16384
    v_mfma_f32_32x32x16_bf16 v[144:159], v[204:207], v[20:23], v[144:159]
    ds_read_b64_tr_b16 v[196:197], v11 offset:55296
    ds_read_b64_tr_b16 v[198:199], v11 offset:55808
    ds_read_b128 v[44:47], v15 offset:16384
    v_xor_b32 v250, 32, v4
    v_lshlrev_b32 v2, 4, v1
    s_mov_b32 vcc_lo, -1
    s_mov_b32 vcc_hi, 0
    s_lshl2_add_u32 s53, s51, s49
    s_lshl_b32 s65, s50, 6
    s_waitcnt lgkmcnt(7)
    v_mfma_f32_32x32x16_bf16 v[128:143], v[208:211], v[24:27], v[128:143]
    s_barrier
    v_add_u32 v10, 0x20000, v5
    ds_read_b64_tr_b16 v[200:201], v10 offset:0
    ds_read_b64_tr_b16 v[202:203], v10 offset:512
    ds_read_b128 v[48:51], v12 offset:32768
    v_add_u32 v160, s65, v239
    v_and_b32 v161, 127, v160
    v_xor_b32 v161, v161, v249
    v_and_b32 v160, 128, v160
    v_mfma_f32_32x32x16_bf16 v[144:159], v[212:215], v[24:27], v[144:159]
    v_add_u32 v11, 0x20000, v6
    ds_read_b64_tr_b16 v[204:205], v11 offset:0
    ds_read_b64_tr_b16 v[206:207], v11 offset:512
    ds_read_b128 v[52:55], v13 offset:32768
    s_cmp_lg_u32 s72, 0
    s_cbranch_scc1 L_d1
    s_add_u32 m0, s59, 0
    s_add_u32 s60, s60, s58
    buffer_load_dwordx4 v3, s[36:39], s60 offen lds
L_d1:
    v_lshl_add_u32 v160, v160, 6, v161
    v_add_u32 v7, v160, v248
    s_waitcnt lgkmcnt(7)
    v_mfma_f32_32x32x16_bf16 v[128:143], v[192:195], v[28:31], v[128:143]
    ds_read_b64_tr_b16 v[208:209], v10 offset:2048
    ds_read_b64_tr_b16 v[210:211], v10 offset:2560
    ds_read_b128 v[56:59], v14 offset:32768
    v_add_u32 v8, 8192, v7
    s_bfe_u32 s65, s56, 0x10007
    s_lshl_b32 s73, s65, 1
    s_lshl_b32 s65, s73, 5
    v_xor_b32 v160, s65, v239
    v_mfma_f32_32x32x16_bf16 v[144:159], v[196:199], v[28:31], v[144:159]
    ds_read_b64_tr_b16 v[212:213], v11 offset:2048
    ds_read_b64_tr_b16 v[214:215], v11 offset:2560
    ds_read_b128 v[60:63], v15 offset:32768
    s_cmp_lg_u32 s72, 0
    s_cbranch_scc1 L_d2
    s_add_u32 m0, s59, 8192
    s_add_u32 s61, s61, s58
    buffer_load_dwordx4 v3, s[40:43], s61 offen lds
L_d2:
    v_xor_b32 v160, v160, v249
    v_and_b32 v161, 16, v1
    s_waitcnt lgkmcnt(7)
    v_mfma_f32_32x32x16_bf16 v[128:143], v[200:203], v[32:35], v[128:143]
    ds_read_b64_tr_b16 v[192:193], v10 offset:4096
    ds_read_b64_tr_b16 v[194:195], v10 offset:4608
    ds_read_b128 v[64:67], v12 offset:49152
    v_lshl_add_u32 v160, v161, 9, v160
    v_add_u32 v9, v160, v248
    v_xor_b32 v243, 32, v9
    v_mfma_f32_32x32x16_bf16 v[144:159], v[204:207], v[32:35], v[144:159]
    ds_read_b64_tr_b16 v[196:197], v11 offset:4096
    ds_read_b64_tr_b16 v[198:199], v11 offset:4608
    ds_read_b128 v[68:71], v13 offset:49152
    s_cmp_lg_u32 s72, 2
    s_cbranch_scc1 L_d3
    s_add_u32 m0, s59, 0
    s_add_u32 s60, s60, s58
    buffer_load_dwordx4 v3, s[36:39], s60 offen lds
L_d3:
    s_waitcnt lgkmcnt(7)
    v_mfma_f32_32x32x16_bf16 v[128:143], v[208:211], v[36:39], v[128:143]
    ds_read_b64_tr_b16 v[200:201], v10 offset:6144
    ds_read_b64_tr_b16 v[202:203], v10 offset:6656
    ds_read_b128 v[72:75], v14 offset:49152
    s_mul_i32 s65, s53, 112
    s_add_u32 s73, s73, s65
    s_lshr_b32 s66, s57, 5
    s_add_u32 s73, s73, s66
    s_lshl_b32 s73, s73, 10
    s_add_u32 s73, s73, 6291456
    v_mfma_f32_32x32x16_bf16 v[144:159], v[212:215], v[36:39], v[144:159]
    ds_read_b64_tr_b16 v[204:205], v11 offset:6144
    ds_read_b64_tr_b16 v[206:207], v11 offset:6656
    ds_read_b128 v[76:79], v15 offset:49152
    s_cmp_lg_u32 s72, 2
    s_cbranch_scc1 L_d4
    s_add_u32 m0, s59, 8192
    s_add_u32 s61, s61, s58
    buffer_load_dwordx4 v3, s[40:43], s61 offen lds
L_d4:
    s_lshl1_add_u32 s65, s50, s65
    s_lshl2_add_u32 s67, s52, s65
    s_lshl_b32 s67, s67, 10
    s_add_u32 s67, s67, 6340608
    s_waitcnt lgkmcnt(7)
    v_mfma_f32_32x32x16_bf16 v[128:143], v[192:195], v[40:43], v[128:143]
    s_cmp_lt_u32 s48, 4
    s_cbranch_scc1 L_nb5
    s_waitcnt vmcnt(4)
L_nb5:
    s_barrier
    ds_read_b64_tr_b16 v[208:209], v10 offset:16384
    ds_read_b64_tr_b16 v[210:211], v10 offset:16896
    v_add_u32 v12, 0x10000, v12
    v_add_u32 v13, 0x10000, v13
    v_add_u32 v14, 0x10000, v14
    v_add_u32 v15, 0x10000, v15
    ds_read_b128 v[80:83], v12 offset:0
    s_lshr_b32 s66, s56, 5
    s_add_u32 s65, s65, s66
    s_lshl_b32 s65, s65, 10
    s_add_u32 s65, s65, 6291456
    v_mfma_f32_32x32x16_bf16 v[144:159], v[196:199], v[40:43], v[144:159]
    ds_read_b64_tr_b16 v[212:213], v11 offset:16384
    ds_read_b64_tr_b16 v[214:215], v11 offset:16896
    ds_read_b128 v[84:87], v13 offset:0
    s_cmp_lg_u32 s72, 0
    s_cbranch_scc1 L_d6
    s_add_u32 m0, s59, 16384
    s_add_u32 s60, s60, s58
    buffer_load_dwordx4 v3, s[36:39], s60 offen lds
    s_add_u32 m0, s59, 24576
    s_add_u32 s61, s61, s58
    buffer_load_dwordx4 v3, s[40:43], s61 offen lds
    s_add_u32 m0, s59, 32768
    s_add_u32 s60, s60, s58
    buffer_load_dwordx4 v3, s[36:39], s60 offen lds
    s_add_u32 m0, s59, 40960
    s_add_u32 s61, s61, s58
    buffer_load_dwordx4 v3, s[40:43], s61 offen lds
L_d6:
    s_waitcnt lgkmcnt(7)
    v_mfma_f32_32x32x16_bf16 v[128:143], v[200:203], v[44:47], v[128:143]
    ds_read_b64_tr_b16 v[192:193], v10 offset:18432
    ds_read_b64_tr_b16 v[194:195], v10 offset:18944
    ds_read_b128 v[88:91], v14 offset:0
    s_lshl1_add_u32 s66, s52, s50
    s_lshl_b32 s66, s66, 7
    s_add_u32 s66, s66, s53
    s_lshl_b32 s66, s66, 11
    s_cmp_ge_u32 s52, 12
    s_cselect_b32 s66, s67, s66
    v_mfma_f32_32x32x16_bf16 v[144:159], v[204:207], v[44:47], v[144:159]
    ds_read_b64_tr_b16 v[196:197], v11 offset:18432
    ds_read_b64_tr_b16 v[198:199], v11 offset:18944
    ds_read_b128 v[92:95], v15 offset:0
    s_lshr_b32 s67, s52, 2
    s_cmp_eq_u32 s67, 1
    s_cselect_b32 s62, s62, 0
    s_cselect_b32 s64, s63, 0
    s_cmp_eq_u32 s67, 2
    s_cselect_b32 s62, s63, s62
    s_waitcnt lgkmcnt(7)
    v_mfma_f32_32x32x16_bf16 v[128:143], v[208:211], v[48:51], v[128:143]
    ds_read_b64_tr_b16 v[200:201], v10 offset:20480
    ds_read_b64_tr_b16 v[202:203], v10 offset:20992
    ds_read_b128 v[96:99], v12 offset:16384
    v_mov_b32 v236, s62
    v_mov_b32 v237, s64
    v_mfma_f32_32x32x16_bf16 v[144:159], v[212:215], v[48:51], v[144:159]
    ds_read_b64_tr_b16 v[204:205], v11 offset:20480
    ds_read_b64_tr_b16 v[206:207], v11 offset:20992
    ds_read_b128 v[100:103], v13 offset:16384
    s_cmp_lg_u32 s72, 2
    s_cbranch_scc1 L_d7
    s_add_u32 m0, s59, 16384
    s_add_u32 s60, s60, s58
    buffer_load_dwordx4 v3, s[36:39], s60 offen lds
    s_add_u32 m0, s59, 24576
    s_add_u32 s61, s61, s58
    buffer_load_dwordx4 v3, s[40:43], s61 offen lds
    s_add_u32 m0, s59, 32768
    s_add_u32 s60, s60, s58
    buffer_load_dwordx4 v3, s[36:39], s60 offen lds
    s_add_u32 m0, s59, 40960
    s_add_u32 s61, s61, s58
    buffer_load_dwordx4 v3, s[40:43], s61 offen lds
L_d7:
    s_waitcnt lgkmcnt(7)
    v_mfma_f32_32x32x16_bf16 v[128:143], v[192:195], v[52:55], v[128:143]
    ds_read_b64_tr_b16 v[208:209], v10 offset:22528
    ds_read_b64_tr_b16 v[210:211], v10 offset:23040
    ds_read_b128 v[104:107], v14 offset:16384
    v_lshrrev_b32 v162, 5, v1
    v_bfe_u32 v160, v1, 2, 2
    v_lshl_add_u32 v160, v162, 2, v160
    v_mfma_f32_32x32x16_bf16 v[144:159], v[196:199], v[52:55], v[144:159]
    ds_read_b64_tr_b16 v[212:213], v11 offset:22528
    ds_read_b64_tr_b16 v[214:215], v11 offset:23040
    ds_read_b128 v[108:111], v15 offset:16384
    v_lshrrev_b32 v161, 1, v160
    v_lshlrev_b32 v161, 3, v161
    v_xor_b32 v161, v161, v239
    s_waitcnt lgkmcnt(7)
    v_mfma_f32_32x32x16_bf16 v[128:143], v[200:203], v[56:59], v[128:143]
    s_waitcnt vmcnt(4)
    s_barrier
    v_add_u32 v10, 0x0, v5
    ds_read_b64_tr_b16 v[192:193], v10 offset:0
    ds_read_b64_tr_b16 v[194:195], v10 offset:512
    ds_read_b128 v[112:115], v12 offset:32768
    s_lshl_b32 s67, s48, 11
    s_add_u32 s67, s67, 114688
    v_lshl_add_u32 v160, v160, 6, v161
    v_add_u32 v249, s67, v160
    v_mfma_f32_32x32x16_bf16 v[144:159], v[204:207], v[56:59], v[144:159]
    v_add_u32 v11, 0x0, v6
    ds_read_b64_tr_b16 v[196:197], v11 offset:0
    ds_read_b64_tr_b16 v[198:199], v11 offset:512
    ds_read_b128 v[116:119], v13 offset:32768
    s_cmp_lg_u32 s72, 0
    s_cbranch_scc1 L_d8
    s_add_u32 m0, s59, 49152
    s_add_u32 s60, s60, s58
    buffer_load_dwordx4 v3, s[36:39], s60 offen lds
    s_add_u32 m0, s59, 57344
    s_add_u32 s61, s61, s58
    buffer_load_dwordx4 v3, s[40:43], s61 offen lds
    s_mov_b32 s60, s56
    s_add_u32 m0, s59, 65536
    s_nop 0
    buffer_load_dwordx4 v4, s[28:31], s60 offen lds
    s_add_u32 m0, s59, 73728
    s_nop 0
    buffer_load_dwordx4 v4, s[32:35], s60 offen lds
L_d8:
    s_waitcnt lgkmcnt(7)
    v_mfma_f32_32x32x16_bf16 v[128:143], v[208:211], v[60:63], v[128:143]
    ds_read_b64_tr_b16 v[200:201], v10 offset:2048
    ds_read_b64_tr_b16 v[202:203], v10 offset:2560
    ds_read_b128 v[120:123], v14 offset:32768
    v_xor_b32 v239, 32, v249
    v_bfe_u32 v160, v1, 1, 3
    v_xor_b32 v160, v160, v162
    v_mfma_f32_32x32x16_bf16 v[144:159], v[212:215], v[60:63], v[144:159]
    ds_read_b64_tr_b16 v[204:205], v11 offset:2048
    ds_read_b64_tr_b16 v[206:207], v11 offset:2560
    ds_read_b128 v[124:127], v15 offset:32768
    v_and_b32 v161, 31, v1
    v_lshlrev_b32 v161, 6, v161
    v_lshl_add_u32 v160, v160, 3, v161
    v_add_u32 v248, s67, v160
    s_waitcnt lgkmcnt(7)
    v_mfma_f32_32x32x16_bf16 v[128:143], v[192:195], v[64:67], v[128:143]
    ds_read_b64_tr_b16 v[208:209], v10 offset:4096
    ds_read_b64_tr_b16 v[210:211], v10 offset:4608
    v_mfma_f32_32x32x16_bf16 v[144:159], v[196:199], v[64:67], v[144:159]
    ds_read_b64_tr_b16 v[212:213], v11 offset:4096
    ds_read_b64_tr_b16 v[214:215], v11 offset:4608
    s_cmp_lg_u32 s72, 2
    s_cbranch_scc1 L_d9
    s_add_u32 m0, s59, 49152
    s_add_u32 s60, s60, s58
    buffer_load_dwordx4 v3, s[36:39], s60 offen lds
    s_add_u32 m0, s59, 57344
    s_add_u32 s61, s61, s58
    buffer_load_dwordx4 v3, s[40:43], s61 offen lds
    s_mov_b32 s60, s56
    s_add_u32 m0, s59, 65536
    s_nop 0
    buffer_load_dwordx4 v4, s[28:31], s60 offen lds
    s_add_u32 m0, s59, 73728
    s_nop 0
    buffer_load_dwordx4 v4, s[32:35], s60 offen lds
L_d9:
    s_waitcnt lgkmcnt(5)
    v_mfma_f32_32x32x16_bf16 v[128:143], v[200:203], v[68:71], v[128:143]
    ds_read_b64_tr_b16 v[192:193], v10 offset:6144
    ds_read_b64_tr_b16 v[194:195], v10 offset:6656
    v_mfma_f32_32x32x16_bf16 v[144:159], v[204:207], v[68:71], v[144:159]
    ds_read_b64_tr_b16 v[196:197], v11 offset:6144
    ds_read_b64_tr_b16 v[198:199], v11 offset:6656
    s_waitcnt lgkmcnt(4)
    v_mfma_f32_32x32x16_bf16 v[128:143], v[208:211], v[72:75], v[128:143]
    s_waitcnt vmcnt(4)
    s_barrier
    v_and_b32 v232, 31, v1
    v_lshlrev_b32 v232, 2, v232
    s_lshl_b32 s68, s49, 7
    s_add_u32 s68, s68, s71
    buffer_load_dword v232, v232, s[44:47], s68 offen sc1
    s_lshl3_add_u32 s68, s2, s48
    s_cmp_lg_u32 s68, 0
    s_cbranch_scc1 L_nofl
    v_mov_b32 v253, 0
    v_mov_b32 v254, 1
    global_store_dword v253, v254, s[20:21] sc1
L_nofl:
    ds_read_b64_tr_b16 v[200:201], v10 offset:16384
    ds_read_b64_tr_b16 v[202:203], v10 offset:16896
    v_mfma_f32_32x32x16_bf16 v[144:159], v[212:215], v[72:75], v[144:159]
    ds_read_b64_tr_b16 v[204:205], v11 offset:16384
    ds_read_b64_tr_b16 v[206:207], v11 offset:16896
    s_cmp_lg_u32 s72, 0
    s_cbranch_scc1 L_d10
    s_add_u32 m0, s59, 81920
    s_add_u32 s60, s60, 229376
    buffer_load_dwordx4 v4, s[28:31], s60 offen lds
L_d10:
    s_waitcnt lgkmcnt(4)
    v_mfma_f32_32x32x16_bf16 v[128:143], v[192:195], v[76:79], v[128:143]
    ds_read_b64_tr_b16 v[208:209], v10 offset:18432
    ds_read_b64_tr_b16 v[210:211], v10 offset:18944
    v_mfma_f32_32x32x16_bf16 v[144:159], v[196:199], v[76:79], v[144:159]
    ds_read_b64_tr_b16 v[212:213], v11 offset:18432
    ds_read_b64_tr_b16 v[214:215], v11 offset:18944
    s_cmp_lg_u32 s72, 0
    s_cbranch_scc1 L_d11
    s_add_u32 m0, s59, 90112
    s_nop 0
    buffer_load_dwordx4 v4, s[32:35], s60 offen lds
L_d11:
    s_waitcnt lgkmcnt(4)
    v_mfma_f32_32x32x16_bf16 v[128:143], v[200:203], v[80:83], v[128:143]
    ds_read_b64_tr_b16 v[192:193], v10 offset:20480
    ds_read_b64_tr_b16 v[194:195], v10 offset:20992
    v_mfma_f32_32x32x16_bf16 v[144:159], v[204:207], v[80:83], v[144:159]
    ds_read_b64_tr_b16 v[196:197], v11 offset:20480
    ds_read_b64_tr_b16 v[198:199], v11 offset:20992
    s_cmp_lg_u32 s72, 2
    s_cbranch_scc1 L_d12
    s_add_u32 m0, s59, 81920
    s_add_u32 s60, s60, 229376
    buffer_load_dwordx4 v4, s[28:31], s60 offen lds
L_d12:
    s_waitcnt lgkmcnt(4)
    v_mfma_f32_32x32x16_bf16 v[128:143], v[208:211], v[84:87], v[128:143]
    ds_read_b64_tr_b16 v[200:201], v10 offset:22528
    ds_read_b64_tr_b16 v[202:203], v10 offset:23040
    v_mfma_f32_32x32x16_bf16 v[144:159], v[212:215], v[84:87], v[144:159]
    ds_read_b64_tr_b16 v[204:205], v11 offset:22528
    ds_read_b64_tr_b16 v[206:207], v11 offset:23040
    s_cmp_lg_u32 s72, 2
    s_cbranch_scc1 L_d13
    s_add_u32 m0, s59, 90112
    s_nop 0
    buffer_load_dwordx4 v4, s[32:35], s60 offen lds
L_d13:
    s_waitcnt lgkmcnt(4)
    v_mfma_f32_32x32x16_bf16 v[128:143], v[192:195], v[88:91], v[128:143]
    ds_read_b64_tr_b16 v[208:209], v10 offset:32768
    ds_read_b64_tr_b16 v[210:211], v10 offset:33280
    v_mfma_f32_32x32x16_bf16 v[144:159], v[196:199], v[88:91], v[144:159]
    ds_read_b64_tr_b16 v[212:213], v11 offset:32768
    ds_read_b64_tr_b16 v[214:215], v11 offset:33280
    s_cmp_lg_u32 s72, 0
    s_cbranch_scc1 L_d14
    s_add_u32 m0, s59, 98304
    s_add_u32 s60, s60, 229376
    buffer_load_dwordx4 v4, s[28:31], s60 offen lds
L_d14:
    s_waitcnt lgkmcnt(4)
    v_mfma_f32_32x32x16_bf16 v[128:143], v[200:203], v[92:95], v[128:143]
    ds_read_b64_tr_b16 v[192:193], v10 offset:34816
    ds_read_b64_tr_b16 v[194:195], v10 offset:35328
    v_mfma_f32_32x32x16_bf16 v[144:159], v[204:207], v[92:95], v[144:159]
    ds_read_b64_tr_b16 v[196:197], v11 offset:34816
    ds_read_b64_tr_b16 v[198:199], v11 offset:35328
    s_cmp_lg_u32 s72, 0
    s_cbranch_scc1 L_d15
    s_add_u32 m0, s59, 106496
    s_nop 0
    buffer_load_dwordx4 v4, s[32:35], s60 offen lds
L_d15:
    s_waitcnt lgkmcnt(4)
    v_mfma_f32_32x32x16_bf16 v[128:143], v[208:211], v[96:99], v[128:143]
    ds_read_b64_tr_b16 v[200:201], v10 offset:36864
    ds_read_b64_tr_b16 v[202:203], v10 offset:37376
    v_mfma_f32_32x32x16_bf16 v[144:159], v[212:215], v[96:99], v[144:159]
    ds_read_b64_tr_b16 v[204:205], v11 offset:36864
    ds_read_b64_tr_b16 v[206:207], v11 offset:37376
    s_cmp_lg_u32 s72, 2
    s_cbranch_scc1 L_d16
    s_add_u32 m0, s59, 98304
    s_add_u32 s60, s60, 229376
    buffer_load_dwordx4 v4, s[28:31], s60 offen lds
L_d16:
    s_waitcnt lgkmcnt(4)
    v_mfma_f32_32x32x16_bf16 v[128:143], v[192:195], v[100:103], v[128:143]
    ds_read_b64_tr_b16 v[208:209], v10 offset:38912
    ds_read_b64_tr_b16 v[210:211], v10 offset:39424
    v_mfma_f32_32x32x16_bf16 v[144:159], v[196:199], v[100:103], v[144:159]
    ds_read_b64_tr_b16 v[212:213], v11 offset:38912
    ds_read_b64_tr_b16 v[214:215], v11 offset:39424
    s_cmp_lg_u32 s72, 2
    s_cbranch_scc1 L_d17
    s_add_u32 m0, s59, 106496
    s_nop 0
    buffer_load_dwordx4 v4, s[32:35], s60 offen lds
L_d17:
    s_waitcnt lgkmcnt(4)
    v_mfma_f32_32x32x16_bf16 v[128:143], v[200:203], v[104:107], v[128:143]
    s_waitcnt vmcnt(5)
    s_barrier
    ds_read_b64_tr_b16 v[192:193], v10 offset:49152
    ds_read_b64_tr_b16 v[194:195], v10 offset:49664
    v_mfma_f32_32x32x16_bf16 v[144:159], v[204:207], v[104:107], v[144:159]
    ds_read_b64_tr_b16 v[196:197], v11 offset:49152
    ds_read_b64_tr_b16 v[198:199], v11 offset:49664
    s_cmp_lg_u32 s72, 0
    s_cbranch_scc1 L_d18
    s_add_u32 m0, s59, 131072
    s_add_u32 s60, s60, 229376
    buffer_load_dwordx4 v4, s[28:31], s60 offen lds
    s_add_u32 m0, s59, 139264
    s_nop 0
    buffer_load_dwordx4 v4, s[32:35], s60 offen lds
    s_add_u32 m0, s59, 147456
    s_add_u32 s60, s60, 229376
    buffer_load_dwordx4 v4, s[28:31], s60 offen lds
    s_add_u32 m0, s59, 155648
    s_nop 0
    buffer_load_dwordx4 v4, s[32:35], s60 offen lds
L_d18:
    s_waitcnt lgkmcnt(4)
    v_mfma_f32_32x32x16_bf16 v[128:143], v[208:211], v[108:111], v[128:143]
    ds_read_b64_tr_b16 v[200:201], v10 offset:51200
    ds_read_b64_tr_b16 v[202:203], v10 offset:51712
    v_mfma_f32_32x32x16_bf16 v[144:159], v[212:215], v[108:111], v[144:159]
    ds_read_b64_tr_b16 v[204:205], v11 offset:51200
    ds_read_b64_tr_b16 v[206:207], v11 offset:51712
    s_waitcnt lgkmcnt(4)
    v_mfma_f32_32x32x16_bf16 v[128:143], v[192:195], v[112:115], v[128:143]
    ds_read_b64_tr_b16 v[208:209], v10 offset:53248
    ds_read_b64_tr_b16 v[210:211], v10 offset:53760
    v_mfma_f32_32x32x16_bf16 v[144:159], v[196:199], v[112:115], v[144:159]
    ds_read_b64_tr_b16 v[212:213], v11 offset:53248
    ds_read_b64_tr_b16 v[214:215], v11 offset:53760
    s_cmp_lg_u32 s72, 2
    s_cbranch_scc1 L_d19
    s_add_u32 m0, s59, 131072
    s_add_u32 s60, s60, 229376
    buffer_load_dwordx4 v4, s[28:31], s60 offen lds
    s_add_u32 m0, s59, 139264
    s_nop 0
    buffer_load_dwordx4 v4, s[32:35], s60 offen lds
    s_add_u32 m0, s59, 147456
    s_add_u32 s60, s60, 229376
    buffer_load_dwordx4 v4, s[28:31], s60 offen lds
    s_add_u32 m0, s59, 155648
    s_nop 0
    buffer_load_dwordx4 v4, s[32:35], s60 offen lds
L_d19:
    s_waitcnt lgkmcnt(4)
    v_mfma_f32_32x32x16_bf16 v[128:143], v[200:203], v[116:119], v[128:143]
    ds_read_b64_tr_b16 v[192:193], v10 offset:55296
    ds_read_b64_tr_b16 v[194:195], v10 offset:55808
    v_mfma_f32_32x32x16_bf16 v[144:159], v[204:207], v[116:119], v[144:159]
    ds_read_b64_tr_b16 v[196:197], v11 offset:55296
    ds_read_b64_tr_b16 v[198:199], v11 offset:55808
    s_waitcnt lgkmcnt(4)
    v_mfma_f32_32x32x16_bf16 v[128:143], v[208:211], v[120:123], v[128:143]
    v_add_u32 v10, 0x10000, v7
    ds_read_b64_tr_b16 v[200:201], v10 offset:0
    ds_read_b64_tr_b16 v[202:203], v10 offset:512
    v_mfma_f32_32x32x16_bf16 v[144:159], v[212:215], v[120:123], v[144:159]
    v_add_u32 v11, 0x10000, v8
    ds_read_b64_tr_b16 v[204:205], v11 offset:0
    ds_read_b64_tr_b16 v[206:207], v11 offset:512
    s_cmp_lg_u32 s72, 0
    s_cbranch_scc1 L_d20
    s_add_u32 m0, s59, 0
    s_add_u32 s60, s60, 229376
    buffer_load_dwordx4 v4, s[28:31], s60 offen lds
L_d20:
    s_waitcnt lgkmcnt(4)
    v_mfma_f32_32x32x16_bf16 v[128:143], v[192:195], v[124:127], v[128:143]
    ds_read_b64_tr_b16 v[208:209], v10 offset:2048
    ds_read_b64_tr_b16 v[210:211], v10 offset:2560
    v_mfma_f32_32x32x16_bf16 v[144:159], v[196:199], v[124:127], v[144:159]
    ds_read_b64_tr_b16 v[212:213], v11 offset:2048
    ds_read_b64_tr_b16 v[214:215], v11 offset:2560
    s_cmp_lg_u32 s72, 0
    s_cbranch_scc1 L_d21
    s_add_u32 m0, s59, 8192
    s_nop 0
    buffer_load_dwordx4 v4, s[32:35], s60 offen lds
L_d21:
    s_cmp_lt_u32 s52, 8
    s_cbranch_scc1 L_pqk
    s_cmp_lt_u32 s52, 12
    s_cbranch_scc1 L_pv
    s_waitcnt lgkmcnt(4)
    v_mfma_f32_32x32x16_bf16 v[160:175], v[200:203], v[16:19], 0
    ds_read_b64_tr_b16 v[192:193], v10 offset:4096
    ds_read_b64_tr_b16 v[194:195], v10 offset:4608
    v_mfma_f32_32x32x16_bf16 v[176:191], v[204:207], v[16:19], 0
    ds_read_b64_tr_b16 v[196:197], v11 offset:4096
    ds_read_b64_tr_b16 v[198:199], v11 offset:4608
    s_cmp_lg_u32 s72, 2
    s_cbranch_scc1 L_d22
    s_add_u32 m0, s59, 0
    s_add_u32 s60, s60, 229376
    buffer_load_dwordx4 v4, s[28:31], s60 offen lds
L_d22:
    s_waitcnt lgkmcnt(4)
    v_mfma_f32_32x32x16_bf16 v[160:175], v[208:211], v[20:23], v[160:175]
    ds_read_b64_tr_b16 v[200:201], v10 offset:6144
    ds_read_b64_tr_b16 v[202:203], v10 offset:6656
    v_mfma_f32_32x32x16_bf16 v[176:191], v[212:215], v[20:23], v[176:191]
    ds_read_b64_tr_b16 v[204:205], v11 offset:6144
    ds_read_b64_tr_b16 v[206:207], v11 offset:6656
    s_cmp_lg_u32 s72, 2
    s_cbranch_scc1 L_d23
    s_add_u32 m0, s59, 8192
    s_nop 0
    buffer_load_dwordx4 v4, s[32:35], s60 offen lds
L_d23:
    s_waitcnt vmcnt(4)
    v_rsq_f32 v234, v232
    s_waitcnt lgkmcnt(4)
    v_mfma_f32_32x32x16_bf16 v[160:175], v[192:195], v[24:27], v[160:175]
    s_waitcnt vmcnt(6)
    s_barrier
    v_mov_b32 v238, 0
    global_load_dword v238, v238, s[20:21] sc1
    ds_read_b64_tr_b16 v[208:209], v10 offset:16384
    ds_read_b64_tr_b16 v[210:211], v10 offset:16896
    v_mul_f32 v233, 0xbfb8aa3b, v234
    v_mfma_f32_32x32x16_bf16 v[176:191], v[196:199], v[24:27], v[176:191]
    ds_read_b64_tr_b16 v[212:213], v11 offset:16384
    ds_read_b64_tr_b16 v[214:215], v11 offset:16896
    s_cmp_lg_u32 s72, 0
    s_cbranch_scc1 L_d24
    s_add_u32 m0, s59, 16384
    s_add_u32 s60, s60, 229376
    buffer_load_dwordx4 v4, s[28:31], s60 offen lds
L_d24:
    s_cmp_lt_u32 s52, 4
    s_cselect_b32 s68, 0x3e8b97f6, 1.0
    v_mul_f32 v234, s68, v234
    s_waitcnt lgkmcnt(4)
    v_mfma_f32_32x32x16_bf16 v[160:175], v[200:203], v[28:31], v[160:175]
    ds_read_b64_tr_b16 v[192:193], v10 offset:18432
    ds_read_b64_tr_b16 v[194:195], v10 offset:18944
    v_mul_f32 v216, v233, v128
    v_mfma_f32_32x32x16_bf16 v[176:191], v[204:207], v[28:31], v[176:191]
    ds_read_b64_tr_b16 v[196:197], v11 offset:18432
    ds_read_b64_tr_b16 v[198:199], v11 offset:18944
    s_cmp_lg_u32 s72, 0
    s_cbranch_scc1 L_d25
    s_add_u32 m0, s59, 24576
    s_nop 0
    buffer_load_dwordx4 v4, s[32:35], s60 offen lds
L_d25:
    v_mul_f32 v217, v233, v129
    v_mul_f32 v218, v233, v130
    s_waitcnt lgkmcnt(4)
    v_mfma_f32_32x32x16_bf16 v[160:175], v[208:211], v[32:35], v[160:175]
    ds_read_b64_tr_b16 v[200:201], v10 offset:20480
    ds_read_b64_tr_b16 v[202:203], v10 offset:20992
    v_mul_f32 v219, v233, v131
    v_mfma_f32_32x32x16_bf16 v[176:191], v[212:215], v[32:35], v[176:191]
    ds_read_b64_tr_b16 v[204:205], v11 offset:20480
    ds_read_b64_tr_b16 v[206:207], v11 offset:20992
    s_cmp_lg_u32 s72, 2
    s_cbranch_scc1 L_d26
    s_add_u32 m0, s59, 16384
    s_add_u32 s60, s60, 229376
    buffer_load_dwordx4 v4, s[28:31], s60 offen lds
L_d26:
    v_exp_f32 v216, v216
    s_waitcnt lgkmcnt(4)
    v_mfma_f32_32x32x16_bf16 v[160:175], v[192:195], v[36:39], v[160:175]
    ds_read_b64_tr_b16 v[208:209], v10 offset:22528
    ds_read_b64_tr_b16 v[210:211], v10 offset:23040
    v_mul_f32 v128, v128, v144
    v_mfma_f32_32x32x16_bf16 v[176:191], v[196:199], v[36:39], v[176:191]
    ds_read_b64_tr_b16 v[212:213], v11 offset:22528
    ds_read_b64_tr_b16 v[214:215], v11 offset:23040
    s_cmp_lg_u32 s72, 2
    s_cbranch_scc1 L_d27
    s_add_u32 m0, s59, 24576
    s_nop 0
    buffer_load_dwordx4 v4, s[32:35], s60 offen lds
L_d27:
    v_exp_f32 v217, v217
    s_waitcnt lgkmcnt(4)
    v_mfma_f32_32x32x16_bf16 v[160:175], v[200:203], v[40:43], v[160:175]
    ds_read_b64_tr_b16 v[192:193], v10 offset:32768
    ds_read_b64_tr_b16 v[194:195], v10 offset:33280
    v_mul_f32 v129, v129, v145
    v_mfma_f32_32x32x16_bf16 v[176:191], v[204:207], v[40:43], v[176:191]
    ds_read_b64_tr_b16 v[196:197], v11 offset:32768
    ds_read_b64_tr_b16 v[198:199], v11 offset:33280
    s_waitcnt lgkmcnt(4)
    v_mfma_f32_32x32x16_bf16 v[160:175], v[208:211], v[44:47], v[160:175]
    ds_read_b64_tr_b16 v[200:201], v10 offset:34816
    ds_read_b64_tr_b16 v[202:203], v10 offset:35328
    v_mfma_f32_32x32x16_bf16 v[176:191], v[212:215], v[44:47], v[176:191]
    ds_read_b64_tr_b16 v[204:205], v11 offset:34816
    ds_read_b64_tr_b16 v[206:207], v11 offset:35328
    s_waitcnt lgkmcnt(4)
    v_mfma_f32_32x32x16_bf16 v[160:175], v[192:195], v[48:51], v[160:175]
    ds_read_b64_tr_b16 v[208:209], v10 offset:36864
    ds_read_b64_tr_b16 v[210:211], v10 offset:37376
    v_mfma_f32_32x32x16_bf16 v[176:191], v[196:199], v[48:51], v[176:191]
    ds_read_b64_tr_b16 v[212:213], v11 offset:36864
    ds_read_b64_tr_b16 v[214:215], v11 offset:37376
    s_waitcnt lgkmcnt(4)
    v_mfma_f32_32x32x16_bf16 v[160:175], v[200:203], v[52:55], v[160:175]
    ds_read_b64_tr_b16 v[192:193], v10 offset:38912
    ds_read_b64_tr_b16 v[194:195], v10 offset:39424
    v_mfma_f32_32x32x16_bf16 v[176:191], v[204:207], v[52:55], v[176:191]
    ds_read_b64_tr_b16 v[196:197], v11 offset:38912
    ds_read_b64_tr_b16 v[198:199], v11 offset:39424
    s_waitcnt lgkmcnt(4)
    v_mfma_f32_32x32x16_bf16 v[160:175], v[208:211], v[56:59], v[160:175]
    s_waitcnt vmcnt(5)
    s_barrier
    v_add_u32 v10, 0x20000, v7
    ds_read_b64_tr_b16 v[200:201], v10 offset:0
    ds_read_b64_tr_b16 v[202:203], v10 offset:512
    v_mfma_f32_32x32x16_bf16 v[176:191], v[212:215], v[56:59], v[176:191]
    v_add_u32 v11, 0x20000, v8
    ds_read_b64_tr_b16 v[204:205], v11 offset:0
    ds_read_b64_tr_b16 v[206:207], v11 offset:512
    s_cmp_lg_u32 s72, 0
    s_cbranch_scc1 L_d28
    s_mov_b32 s60, s57
    s_add_u32 m0, s59, 32768
    s_nop 0
    buffer_load_dwordx4 v4, s[28:31], s60 offen lds
    s_add_u32 m0, s59, 40960
    s_nop 0
    buffer_load_dwordx4 v250, s[32:35], s60 offen lds
    s_add_u32 m0, s59, 49152
    s_add_u32 s60, s60, 229376
    buffer_load_dwordx4 v4, s[28:31], s60 offen lds
    s_add_u32 m0, s59, 57344
    s_nop 0
    buffer_load_dwordx4 v250, s[32:35], s60 offen lds
L_d28:
    s_waitcnt lgkmcnt(4)
    v_mfma_f32_32x32x16_bf16 v[160:175], v[192:195], v[60:63], v[160:175]
    ds_read_b64_tr_b16 v[208:209], v10 offset:2048
    ds_read_b64_tr_b16 v[210:211], v10 offset:2560
    v_mfma_f32_32x32x16_bf16 v[176:191], v[196:199], v[60:63], v[176:191]
    ds_read_b64_tr_b16 v[212:213], v11 offset:2048
    ds_read_b64_tr_b16 v[214:215], v11 offset:2560
    s_waitcnt lgkmcnt(4)
    v_mfma_f32_32x32x16_bf16 v[160:175], v[200:203], v[64:67], v[160:175]
    ds_read_b64_tr_b16 v[192:193], v10 offset:4096
    ds_read_b64_tr_b16 v[194:195], v10 offset:4608
    v_mfma_f32_32x32x16_bf16 v[176:191], v[204:207], v[64:67], v[176:191]
    ds_read_b64_tr_b16 v[196:197], v11 offset:4096
    ds_read_b64_tr_b16 v[198:199], v11 offset:4608
    s_cmp_lg_u32 s72, 2
    s_cbranch_scc1 L_d29
    s_mov_b32 s60, s57
    s_add_u32 m0, s59, 32768
    s_nop 0
    buffer_load_dwordx4 v4, s[28:31], s60 offen lds
    s_add_u32 m0, s59, 40960
    s_nop 0
    buffer_load_dwordx4 v250, s[32:35], s60 offen lds
    s_add_u32 m0, s59, 49152
    s_add_u32 s60, s60, 229376
    buffer_load_dwordx4 v4, s[28:31], s60 offen lds
    s_add_u32 m0, s59, 57344
    s_nop 0
    buffer_load_dwordx4 v250, s[32:35], s60 offen lds
L_d29:
    s_waitcnt lgkmcnt(4)
    v_mfma_f32_32x32x16_bf16 v[160:175], v[208:211], v[68:71], v[160:175]
    ds_read_b64_tr_b16 v[200:201], v10 offset:6144
    ds_read_b64_tr_b16 v[202:203], v10 offset:6656
    v_mfma_f32_32x32x16_bf16 v[176:191], v[212:215], v[68:71], v[176:191]
    ds_read_b64_tr_b16 v[204:205], v11 offset:6144
    ds_read_b64_tr_b16 v[206:207], v11 offset:6656
    s_waitcnt lgkmcnt(4)
    v_mfma_f32_32x32x16_bf16 v[160:175], v[192:195], v[72:75], v[160:175]
    ds_read_b64_tr_b16 v[208:209], v10 offset:16384
    ds_read_b64_tr_b16 v[210:211], v10 offset:16896
    v_mfma_f32_32x32x16_bf16 v[176:191], v[196:199], v[72:75], v[176:191]
    ds_read_b64_tr_b16 v[212:213], v11 offset:16384
    ds_read_b64_tr_b16 v[214:215], v11 offset:16896
    s_cmp_lg_u32 s72, 0
    s_cbranch_scc1 L_d30
    s_add_u32 m0, s59, 65536
    s_add_u32 s60, s60, 229376
    buffer_load_dwordx4 v4, s[28:31], s60 offen lds
L_d30:
    v_exp_f32 v218, v218
    s_waitcnt lgkmcnt(4)
    v_mfma_f32_32x32x16_bf16 v[160:175], v[200:203], v[76:79], v[160:175]
    ds_read_b64_tr_b16 v[192:193], v10 offset:18432
    ds_read_b64_tr_b16 v[194:195], v10 offset:18944
    v_mul_f32 v130, v130, v146
    v_mfma_f32_32x32x16_bf16 v[176:191], v[204:207], v[76:79], v[176:191]
    ds_read_b64_tr_b16 v[196:197], v11 offset:18432
    ds_read_b64_tr_b16 v[198:199], v11 offset:18944
    s_cmp_lg_u32 s72, 0
    s_cbranch_scc1 L_d31
    s_add_u32 m0, s59, 73728
    s_nop 0
    buffer_load_dwordx4 v250, s[32:35], s60 offen lds
L_d31:
    v_exp_f32 v219, v219
    s_waitcnt lgkmcnt(4)
    v_mfma_f32_32x32x16_bf16 v[160:175], v[208:211], v[80:83], v[160:175]
    ds_read_b64_tr_b16 v[200:201], v10 offset:20480
    ds_read_b64_tr_b16 v[202:203], v10 offset:20992
    v_mul_f32 v131, v131, v147
    v_mfma_f32_32x32x16_bf16 v[176:191], v[212:215], v[80:83], v[176:191]
    ds_read_b64_tr_b16 v[204:205], v11 offset:20480
    ds_read_b64_tr_b16 v[206:207], v11 offset:20992
    s_cmp_lg_u32 s72, 2
    s_cbranch_scc1 L_d32
    s_add_u32 m0, s59, 65536
    s_add_u32 s60, s60, 229376
    buffer_load_dwordx4 v4, s[28:31], s60 offen lds
L_d32:
    v_fma_f32 v216, v216, v232, v232
    v_fma_f32 v217, v217, v232, v232
    s_waitcnt lgkmcnt(4)
    v_mfma_f32_32x32x16_bf16 v[160:175], v[192:195], v[84:87], v[160:175]
    ds_read_b64_tr_b16 v[208:209], v10 offset:22528
    ds_read_b64_tr_b16 v[210:211], v10 offset:23040
    v_fma_f32 v218, v218, v232, v232
    v_mfma_f32_32x32x16_bf16 v[176:191], v[196:199], v[84:87], v[176:191]
    ds_read_b64_tr_b16 v[212:213], v11 offset:22528
    ds_read_b64_tr_b16 v[214:215], v11 offset:23040
    s_cmp_lg_u32 s72, 2
    s_cbranch_scc1 L_d33
    s_add_u32 m0, s59, 73728
    s_nop 0
    buffer_load_dwordx4 v250, s[32:35], s60 offen lds
L_d33:
    s_waitcnt lgkmcnt(4)
    v_mfma_f32_32x32x16_bf16 v[160:175], v[200:203], v[88:91], v[160:175]
    s_waitcnt vmcnt(6)
    s_barrier
    v_add_u32 v10, 0x0, v7
    ds_read_b64_tr_b16 v[192:193], v10 offset:0
    ds_read_b64_tr_b16 v[194:195], v10 offset:512
    v_fma_f32 v219, v219, v232, v232
    v_mfma_f32_32x32x16_bf16 v[176:191], v[204:207], v[88:91], v[176:191]
    v_add_u32 v11, 0x0, v8
    ds_read_b64_tr_b16 v[196:197], v11 offset:0
    ds_read_b64_tr_b16 v[198:199], v11 offset:512
    s_cmp_lg_u32 s72, 0
    s_cbranch_scc1 L_d34
    s_add_u32 m0, s59, 81920
    s_add_u32 s60, s60, 229376
    buffer_load_dwordx4 v4, s[28:31], s60 offen lds
    s_add_u32 m0, s59, 90112
    s_nop 0
    buffer_load_dwordx4 v250, s[32:35], s60 offen lds
    s_add_u32 m0, s59, 98304
    s_add_u32 s60, s60, 229376
    buffer_load_dwordx4 v4, s[28:31], s60 offen lds
    s_add_u32 m0, s59, 106496
    s_nop 0
    buffer_load_dwordx4 v250, s[32:35], s60 offen lds
L_d34:
    s_waitcnt lgkmcnt(4)
    v_mfma_f32_32x32x16_bf16 v[160:175], v[208:211], v[92:95], v[160:175]
    ds_read_b64_tr_b16 v[200:201], v10 offset:2048
    ds_read_b64_tr_b16 v[202:203], v10 offset:2560
    v_mfma_f32_32x32x16_bf16 v[176:191], v[212:215], v[92:95], v[176:191]
    ds_read_b64_tr_b16 v[204:205], v11 offset:2048
    ds_read_b64_tr_b16 v[206:207], v11 offset:2560
    s_waitcnt lgkmcnt(4)
    v_mfma_f32_32x32x16_bf16 v[160:175], v[192:195], v[96:99], v[160:175]
    ds_read_b64_tr_b16 v[208:209], v10 offset:4096
    ds_read_b64_tr_b16 v[210:211], v10 offset:4608
    v_mfma_f32_32x32x16_bf16 v[176:191], v[196:199], v[96:99], v[176:191]
    ds_read_b64_tr_b16 v[212:213], v11 offset:4096
    ds_read_b64_tr_b16 v[214:215], v11 offset:4608
    s_cmp_lg_u32 s72, 2
    s_cbranch_scc1 L_d35
    s_add_u32 m0, s59, 81920
    s_add_u32 s60, s60, 229376
    buffer_load_dwordx4 v4, s[28:31], s60 offen lds
    s_add_u32 m0, s59, 90112
    s_nop 0
    buffer_load_dwordx4 v250, s[32:35], s60 offen lds
    s_add_u32 m0, s59, 98304
    s_add_u32 s60, s60, 229376
    buffer_load_dwordx4 v4, s[28:31], s60 offen lds
    s_add_u32 m0, s59, 106496
    s_nop 0
    buffer_load_dwordx4 v250, s[32:35], s60 offen lds
L_d35:
    s_waitcnt lgkmcnt(4)
    v_mfma_f32_32x32x16_bf16 v[160:175], v[200:203], v[100:103], v[160:175]
    ds_read_b64_tr_b16 v[192:193], v10 offset:6144
    ds_read_b64_tr_b16 v[194:195], v10 offset:6656
    v_mfma_f32_32x32x16_bf16 v[176:191], v[204:207], v[100:103], v[176:191]
    ds_read_b64_tr_b16 v[196:197], v11 offset:6144
    ds_read_b64_tr_b16 v[198:199], v11 offset:6656
    s_waitcnt lgkmcnt(4)
    v_mfma_f32_32x32x16_bf16 v[160:175], v[208:211], v[104:107], v[160:175]
    ds_read_b64_tr_b16 v[200:201], v10 offset:16384
    ds_read_b64_tr_b16 v[202:203], v10 offset:16896
    v_mfma_f32_32x32x16_bf16 v[176:191], v[212:215], v[104:107], v[176:191]
    ds_read_b64_tr_b16 v[204:205], v11 offset:16384
    ds_read_b64_tr_b16 v[206:207], v11 offset:16896
    s_cmp_lg_u32 s72, 0
    s_cbranch_scc1 L_d36
    s_add_u32 m0, s59, 131072
    s_add_u32 s60, s60, 229376
    buffer_load_dwordx4 v4, s[28:31], s60 offen lds
L_d36:
    v_rcp_f32 v216, v216
    s_waitcnt lgkmcnt(4)
    v_mfma_f32_32x32x16_bf16 v[160:175], v[192:195], v[108:111], v[160:175]
    ds_read_b64_tr_b16 v[208:209], v10 offset:18432
    ds_read_b64_tr_b16 v[210:211], v10 offset:18944
    v_mfma_f32_32x32x16_bf16 v[176:191], v[196:199], v[108:111], v[176:191]
    ds_read_b64_tr_b16 v[212:213], v11 offset:18432
    ds_read_b64_tr_b16 v[214:215], v11 offset:18944
    s_cmp_lg_u32 s72, 0
    s_cbranch_scc1 L_d37
    s_add_u32 m0, s59, 139264
    s_nop 0
    buffer_load_dwordx4 v250, s[32:35], s60 offen lds
L_d37:
    v_rcp_f32 v217, v217
    s_waitcnt lgkmcnt(4)
    v_mfma_f32_32x32x16_bf16 v[160:175], v[200:203], v[112:115], v[160:175]
    ds_read_b64_tr_b16 v[192:193], v10 offset:20480
    ds_read_b64_tr_b16 v[194:195], v10 offset:20992
    v_mfma_f32_32x32x16_bf16 v[176:191], v[204:207], v[112:115], v[176:191]
    ds_read_b64_tr_b16 v[196:197], v11 offset:20480
    ds_read_b64_tr_b16 v[198:199], v11 offset:20992
    s_cmp_lg_u32 s72, 2
    s_cbranch_scc1 L_d38
    s_add_u32 m0, s59, 131072
    s_add_u32 s60, s60, 229376
    buffer_load_dwordx4 v4, s[28:31], s60 offen lds
L_d38:
    v_rcp_f32 v218, v218
    s_waitcnt lgkmcnt(4)
    v_mfma_f32_32x32x16_bf16 v[160:175], v[208:211], v[116:119], v[160:175]
    ds_read_b64_tr_b16 v[200:201], v10 offset:22528
    ds_read_b64_tr_b16 v[202:203], v10 offset:23040
    v_mfma_f32_32x32x16_bf16 v[176:191], v[212:215], v[116:119], v[176:191]
    ds_read_b64_tr_b16 v[204:205], v11 offset:22528
    ds_read_b64_tr_b16 v[206:207], v11 offset:23040
    s_cmp_lg_u32 s72, 2
    s_cbranch_scc1 L_d39
    s_add_u32 m0, s59, 139264
    s_nop 0
    buffer_load_dwordx4 v250, s[32:35], s60 offen lds
L_d39:
    v_rcp_f32 v219, v219
    s_waitcnt lgkmcnt(4)
    v_mfma_f32_32x32x16_bf16 v[160:175], v[192:195], v[120:123], v[160:175]
    s_waitcnt vmcnt(8)
    s_barrier
    v_lshrrev_b32 v253, 2, v2
    v_add_u32 v253, 163584, v253
    v_mov_b32 v254, 0
    ds_write_b32 v253, v254
    v_add_u32 v10, 0x0, v9
    ds_read_b64_tr_b16 v[208:209], v10 offset:32768
    ds_read_b64_tr_b16 v[210:211], v10 offset:33280
    v_mul_f32 v128, v128, v216
    v_mfma_f32_32x32x16_bf16 v[176:191], v[196:199], v[120:123], v[176:191]
    v_add_u32 v11, 0x0, v243
    ds_read_b64_tr_b16 v[212:213], v11 offset:32768
    ds_read_b64_tr_b16 v[214:215], v11 offset:33280
    s_cmp_lg_u32 s72, 0
    s_cbranch_scc1 L_d40
    s_add_u32 m0, s59, 114688
    s_add_u32 s60, s60, 229376
    buffer_load_dwordx4 v4, s[28:31], s60 offen lds
    s_add_u32 m0, s59, 122880
    s_nop 0
    buffer_load_dwordx4 v250, s[32:35], s60 offen lds
L_d40:
    v_mul_f32 v129, v129, v217
    s_waitcnt lgkmcnt(5)
    v_mfma_f32_32x32x16_bf16 v[160:175], v[200:203], v[124:127], v[160:175]
    ds_read_b64_tr_b16 v[192:193], v10 offset:34816
    ds_read_b64_tr_b16 v[194:195], v10 offset:35328
    v_mul_f32 v130, v130, v218
    v_mfma_f32_32x32x16_bf16 v[176:191], v[204:207], v[124:127], v[176:191]
    ds_read_b64_tr_b16 v[196:197], v11 offset:34816
    ds_read_b64_tr_b16 v[198:199], v11 offset:35328
    v_mul_f32 v131, v131, v219
    v_cvt_pk_bf16_f32 v144, v128, v129
    v_cvt_pk_bf16_f32 v145, v130, v131
    v_mul_f32 v220, v233, v132
    v_mul_f32 v221, v233, v133
    v_mul_f32 v222, v233, v134
    v_mul_f32 v223, v233, v135
    v_exp_f32 v220, v220
    v_mul_f32 v132, v132, v148
    v_exp_f32 v221, v221
    v_mul_f32 v133, v133, v149
    v_exp_f32 v222, v222
    v_mul_f32 v134, v134, v150
    v_exp_f32 v223, v223
    v_mul_f32 v135, v135, v151
    v_fma_f32 v220, v220, v232, v232
    v_fma_f32 v221, v221, v232, v232
    v_fma_f32 v222, v222, v232, v232
    v_fma_f32 v223, v223, v232, v232
    v_rcp_f32 v220, v220
    v_rcp_f32 v221, v221
    v_rcp_f32 v222, v222
    v_rcp_f32 v223, v223
    v_mul_f32 v132, v132, v220
    v_mul_f32 v133, v133, v221
    v_mul_f32 v134, v134, v222
    v_mul_f32 v135, v135, v223
    v_cvt_pk_bf16_f32 v146, v132, v133
    v_cvt_pk_bf16_f32 v147, v134, v135
    buffer_store_dwordx4 v[144:147], v2, s[44:47], s66 offen offset:0 sc1
    v_mul_f32 v216, v233, v136
    v_mul_f32 v217, v233, v137
    v_mul_f32 v218, v233, v138
    v_mul_f32 v219, v233, v139
    v_exp_f32 v216, v216
    v_mul_f32 v136, v136, v152
    v_exp_f32 v217, v217
    v_mul_f32 v137, v137, v153
    v_exp_f32 v218, v218
    v_mul_f32 v138, v138, v154
    v_exp_f32 v219, v219
    v_mul_f32 v139, v139, v155
    v_fma_f32 v216, v216, v232, v232
    v_fma_f32 v217, v217, v232, v232
    v_fma_f32 v218, v218, v232, v232
    v_fma_f32 v219, v219, v232, v232
    v_rcp_f32 v216, v216
    v_rcp_f32 v217, v217
    v_rcp_f32 v218, v218
    v_rcp_f32 v219, v219
    v_mul_f32 v136, v136, v216
    v_mul_f32 v137, v137, v217
    v_mul_f32 v138, v138, v218
    v_mul_f32 v139, v139, v219
    v_cvt_pk_bf16_f32 v152, v136, v137
    v_cvt_pk_bf16_f32 v153, v138, v139
    v_mul_f32 v220, v233, v140
    v_mul_f32 v221, v233, v141
    v_mul_f32 v222, v233, v142
    v_mul_f32 v223, v233, v143
    v_exp_f32 v220, v220
    v_mul_f32 v140, v140, v156
    v_exp_f32 v221, v221
    v_mul_f32 v141, v141, v157
    v_exp_f32 v222, v222
    v_mul_f32 v142, v142, v158
    v_exp_f32 v223, v223
    v_mul_f32 v143, v143, v159
    v_fma_f32 v220, v220, v232, v232
    v_fma_f32 v221, v221, v232, v232
    v_fma_f32 v222, v222, v232, v232
    v_fma_f32 v223, v223, v232, v232
    v_rcp_f32 v220, v220
    v_rcp_f32 v221, v221
    v_rcp_f32 v222, v222
    v_rcp_f32 v223, v223
    v_mul_f32 v140, v140, v220
    v_mul_f32 v141, v141, v221
    v_mul_f32 v142, v142, v222
    v_mul_f32 v143, v143, v223
    v_cvt_pk_bf16_f32 v154, v140, v141
    v_cvt_pk_bf16_f32 v155, v142, v143
    buffer_store_dwordx4 v[152:155], v2, s[44:47], s66 offen offset:1024 sc1
    s_branch L_r2
L_pqk:
    s_waitcnt lgkmcnt(4)
    v_mfma_f32_32x32x16_bf16 v[160:175], v[200:203], v[16:19], 0
    ds_read_b64_tr_b16 v[192:193], v10 offset:4096
    ds_read_b64_tr_b16 v[194:195], v10 offset:4608
    v_mfma_f32_32x32x16_bf16 v[176:191], v[204:207], v[16:19], 0
    ds_read_b64_tr_b16 v[196:197], v11 offset:4096
    ds_read_b64_tr_b16 v[198:199], v11 offset:4608
    s_cmp_lg_u32 s72, 2
    s_cbranch_scc1 L_d41
    s_add_u32 m0, s59, 0
    s_add_u32 s60, s60, 229376
    buffer_load_dwordx4 v4, s[28:31], s60 offen lds
L_d41:
    s_waitcnt lgkmcnt(4)
    v_mfma_f32_32x32x16_bf16 v[160:175], v[208:211], v[20:23], v[160:175]
    ds_read_b64_tr_b16 v[200:201], v10 offset:6144
    ds_read_b64_tr_b16 v[202:203], v10 offset:6656
    v_mfma_f32_32x32x16_bf16 v[176:191], v[212:215], v[20:23], v[176:191]
    ds_read_b64_tr_b16 v[204:205], v11 offset:6144
    ds_read_b64_tr_b16 v[206:207], v11 offset:6656
    s_cmp_lg_u32 s72, 2
    s_cbranch_scc1 L_d42
    s_add_u32 m0, s59, 8192
    s_nop 0
    buffer_load_dwordx4 v4, s[32:35], s60 offen lds
L_d42:
    s_waitcnt vmcnt(4)
    v_rsq_f32 v234, v232
    s_waitcnt lgkmcnt(4)
    v_mfma_f32_32x32x16_bf16 v[160:175], v[192:195], v[24:27], v[160:175]
    s_waitcnt vmcnt(6)
    s_barrier
    v_mov_b32 v238, 0
    global_load_dword v238, v238, s[20:21] sc1
    ds_read_b64_tr_b16 v[208:209], v10 offset:16384
    ds_read_b64_tr_b16 v[210:211], v10 offset:16896
    v_mul_f32 v233, 0xbfb8aa3b, v234
    s_cmp_lt_u32 s52, 4
    s_cselect_b32 s68, 0x3e8b97f6, 1.0
    v_mul_f32 v234, s68, v234
    v_mul_f32 v128, v234, v128
    v_mul_f32 v129, v234, v129
    v_mul_f32 v130, v234, v130
    v_mul_f32 v131, v234, v131
    v_cvt_pk_bf16_f32 v224, v128, v129
    v_mfma_f32_32x32x16_bf16 v[176:191], v[196:199], v[24:27], v[176:191]
    ds_read_b64_tr_b16 v[212:213], v11 offset:16384
    ds_read_b64_tr_b16 v[214:215], v11 offset:16896
    s_cmp_lg_u32 s72, 0
    s_cbranch_scc1 L_d43
    s_add_u32 m0, s59, 16384
    s_add_u32 s60, s60, 229376
    buffer_load_dwordx4 v4, s[28:31], s60 offen lds
L_d43:
    v_cvt_pk_bf16_f32 v225, v130, v131
    v_mul_f32 v132, v234, v132
    s_waitcnt lgkmcnt(4)
    v_mfma_f32_32x32x16_bf16 v[160:175], v[200:203], v[28:31], v[160:175]
    ds_read_b64_tr_b16 v[192:193], v10 offset:18432
    ds_read_b64_tr_b16 v[194:195], v10 offset:18944
    v_mul_f32 v133, v234, v133
    v_mul_f32 v134, v234, v134
    v_mul_f32 v135, v234, v135
    v_cvt_pk_bf16_f32 v226, v132, v133
    v_cvt_pk_bf16_f32 v227, v134, v135
    buffer_store_dwordx4 v[224:227], v2, s[44:47], s66 offen offset:0 sc1
    v_mul_f32 v136, v234, v136
    v_mfma_f32_32x32x16_bf16 v[176:191], v[204:207], v[28:31], v[176:191]
    ds_read_b64_tr_b16 v[196:197], v11 offset:18432
    ds_read_b64_tr_b16 v[198:199], v11 offset:18944
    s_cmp_lg_u32 s72, 0
    s_cbranch_scc1 L_d44
    s_add_u32 m0, s59, 24576
    s_nop 0
    buffer_load_dwordx4 v4, s[32:35], s60 offen lds
L_d44:
    v_mul_f32 v137, v234, v137
    v_mul_f32 v138, v234, v138
    s_waitcnt lgkmcnt(4)
    v_mfma_f32_32x32x16_bf16 v[160:175], v[208:211], v[32:35], v[160:175]
    ds_read_b64_tr_b16 v[200:201], v10 offset:20480
    ds_read_b64_tr_b16 v[202:203], v10 offset:20992
    v_mul_f32 v139, v234, v139
    v_cvt_pk_bf16_f32 v228, v136, v137
    v_cvt_pk_bf16_f32 v229, v138, v139
    v_mul_f32 v140, v234, v140
    v_mul_f32 v141, v234, v141
    v_mul_f32 v142, v234, v142
    v_mul_f32 v143, v234, v143
    v_cvt_pk_bf16_f32 v230, v140, v141
    v_mfma_f32_32x32x16_bf16 v[176:191], v[212:215], v[32:35], v[176:191]
    ds_read_b64_tr_b16 v[204:205], v11 offset:20480
    ds_read_b64_tr_b16 v[206:207], v11 offset:20992
    s_cmp_lg_u32 s72, 2
    s_cbranch_scc1 L_d45
    s_add_u32 m0, s59, 16384
    s_add_u32 s60, s60, 229376
    buffer_load_dwordx4 v4, s[28:31], s60 offen lds
L_d45:
    v_cvt_pk_bf16_f32 v231, v142, v143
    v_cndmask_b32 v230, v236, v230, vcc
    s_waitcnt lgkmcnt(4)
    v_mfma_f32_32x32x16_bf16 v[160:175], v[192:195], v[36:39], v[160:175]
    ds_read_b64_tr_b16 v[208:209], v10 offset:22528
    ds_read_b64_tr_b16 v[210:211], v10 offset:23040
    v_cndmask_b32 v231, v237, v231, vcc
    buffer_store_dwordx4 v[228:231], v2, s[44:47], s66 offen offset:1024 sc1
    s_add_u32 s66, s66, 131072
    v_mul_f32 v144, v234, v144
    v_mul_f32 v145, v234, v145
    v_mul_f32 v146, v234, v146
    v_mul_f32 v147, v234, v147
    v_mfma_f32_32x32x16_bf16 v[176:191], v[196:199], v[36:39], v[176:191]
    ds_read_b64_tr_b16 v[212:213], v11 offset:22528
    ds_read_b64_tr_b16 v[214:215], v11 offset:23040
    s_cmp_lg_u32 s72, 2
    s_cbranch_scc1 L_d46
    s_add_u32 m0, s59, 24576
    s_nop 0
    buffer_load_dwordx4 v4, s[32:35], s60 offen lds
L_d46:
    v_cvt_pk_bf16_f32 v224, v144, v145
    v_cvt_pk_bf16_f32 v225, v146, v147
    s_waitcnt lgkmcnt(4)
    v_mfma_f32_32x32x16_bf16 v[160:175], v[200:203], v[40:43], v[160:175]
    ds_read_b64_tr_b16 v[192:193], v10 offset:32768
    ds_read_b64_tr_b16 v[194:195], v10 offset:33280
    v_mul_f32 v148, v234, v148
    v_mul_f32 v149, v234, v149
    v_mul_f32 v150, v234, v150
    v_mul_f32 v151, v234, v151
    v_cvt_pk_bf16_f32 v226, v148, v149
    v_cvt_pk_bf16_f32 v227, v150, v151
    buffer_store_dwordx4 v[224:227], v2, s[44:47], s66 offen offset:0 sc1
    v_mfma_f32_32x32x16_bf16 v[176:191], v[204:207], v[40:43], v[176:191]
    ds_read_b64_tr_b16 v[196:197], v11 offset:32768
    ds_read_b64_tr_b16 v[198:199], v11 offset:33280
    v_mul_f32 v152, v234, v152
    v_mul_f32 v153, v234, v153
    v_mul_f32 v154, v234, v154
    v_mul_f32 v155, v234, v155
    v_cvt_pk_bf16_f32 v228, v152, v153
    v_cvt_pk_bf16_f32 v229, v154, v155
    v_mul_f32 v156, v234, v156
    v_mul_f32 v157, v234, v157
    s_waitcnt lgkmcnt(4)
    v_mfma_f32_32x32x16_bf16 v[160:175], v[208:211], v[44:47], v[160:175]
    ds_read_b64_tr_b16 v[200:201], v10 offset:34816
    ds_read_b64_tr_b16 v[202:203], v10 offset:35328
    v_mul_f32 v158, v234, v158
    v_mul_f32 v159, v234, v159
    v_cvt_pk_bf16_f32 v230, v156, v157
    v_cvt_pk_bf16_f32 v231, v158, v159
    v_cndmask_b32 v230, v236, v230, vcc
    v_cndmask_b32 v231, v237, v231, vcc
    buffer_store_dwordx4 v[228:231], v2, s[44:47], s66 offen offset:1024 sc1
    v_mfma_f32_32x32x16_bf16 v[176:191], v[212:215], v[44:47], v[176:191]
    ds_read_b64_tr_b16 v[204:205], v11 offset:34816
    ds_read_b64_tr_b16 v[206:207], v11 offset:35328
    s_add_u32 s66, s66, 131072
    s_waitcnt lgkmcnt(4)
    v_mfma_f32_32x32x16_bf16 v[160:175], v[192:195], v[48:51], v[160:175]
    ds_read_b64_tr_b16 v[208:209], v10 offset:36864
    ds_read_b64_tr_b16 v[210:211], v10 offset:37376
    v_mfma_f32_32x32x16_bf16 v[176:191], v[196:199], v[48:51], v[176:191]
    ds_read_b64_tr_b16 v[212:213], v11 offset:36864
    ds_read_b64_tr_b16 v[214:215], v11 offset:37376
    s_waitcnt lgkmcnt(4)
    v_mfma_f32_32x32x16_bf16 v[160:175], v[200:203], v[52:55], v[160:175]
    ds_read_b64_tr_b16 v[192:193], v10 offset:38912
    ds_read_b64_tr_b16 v[194:195], v10 offset:39424
    v_mfma_f32_32x32x16_bf16 v[176:191], v[204:207], v[52:55], v[176:191]
    ds_read_b64_tr_b16 v[196:197], v11 offset:38912
    ds_read_b64_tr_b16 v[198:199], v11 offset:39424
    s_waitcnt lgkmcnt(4)
    v_mfma_f32_32x32x16_bf16 v[160:175], v[208:211], v[56:59], v[160:175]
    s_waitcnt vmcnt(9)
    s_barrier
    v_add_u32 v10, 0x20000, v7
    ds_read_b64_tr_b16 v[200:201], v10 offset:0
    ds_read_b64_tr_b16 v[202:203], v10 offset:512
    v_mfma_f32_32x32x16_bf16 v[176:191], v[212:215], v[56:59], v[176:191]
    v_add_u32 v11, 0x20000, v8
    ds_read_b64_tr_b16 v[204:205], v11 offset:0
    ds_read_b64_tr_b16 v[206:207], v11 offset:512
    s_cmp_lg_u32 s72, 0
    s_cbranch_scc1 L_d47
    s_mov_b32 s60, s57
    s_add_u32 m0, s59, 32768
    s_nop 0
    buffer_load_dwordx4 v4, s[28:31], s60 offen lds
    s_add_u32 m0, s59, 40960
    s_nop 0
    buffer_load_dwordx4 v250, s[32:35], s60 offen lds
    s_add_u32 m0, s59, 49152
    s_add_u32 s60, s60, 229376
    buffer_load_dwordx4 v4, s[28:31], s60 offen lds
    s_add_u32 m0, s59, 57344
    s_nop 0
    buffer_load_dwordx4 v250, s[32:35], s60 offen lds
L_d47:
    s_waitcnt lgkmcnt(4)
    v_mfma_f32_32x32x16_bf16 v[160:175], v[192:195], v[60:63], v[160:175]
    ds_read_b64_tr_b16 v[208:209], v10 offset:2048
    ds_read_b64_tr_b16 v[210:211], v10 offset:2560
    v_mfma_f32_32x32x16_bf16 v[176:191], v[196:199], v[60:63], v[176:191]
    ds_read_b64_tr_b16 v[212:213], v11 offset:2048
    ds_read_b64_tr_b16 v[214:215], v11 offset:2560
    s_waitcnt lgkmcnt(4)
    v_mfma_f32_32x32x16_bf16 v[160:175], v[200:203], v[64:67], v[160:175]
    ds_read_b64_tr_b16 v[192:193], v10 offset:4096
    ds_read_b64_tr_b16 v[194:195], v10 offset:4608
    v_mfma_f32_32x32x16_bf16 v[176:191], v[204:207], v[64:67], v[176:191]
    ds_read_b64_tr_b16 v[196:197], v11 offset:4096
    ds_read_b64_tr_b16 v[198:199], v11 offset:4608
    s_cmp_lg_u32 s72, 2
    s_cbranch_scc1 L_d48
    s_mov_b32 s60, s57
    s_add_u32 m0, s59, 32768
    s_nop 0
    buffer_load_dwordx4 v4, s[28:31], s60 offen lds
    s_add_u32 m0, s59, 40960
    s_nop 0
    buffer_load_dwordx4 v250, s[32:35], s60 offen lds
    s_add_u32 m0, s59, 49152
    s_add_u32 s60, s60, 229376
    buffer_load_dwordx4 v4, s[28:31], s60 offen lds
    s_add_u32 m0, s59, 57344
    s_nop 0
    buffer_load_dwordx4 v250, s[32:35], s60 offen lds
L_d48:
    s_waitcnt lgkmcnt(4)
    v_mfma_f32_32x32x16_bf16 v[160:175], v[208:211], v[68:71], v[160:175]
    ds_read_b64_tr_b16 v[200:201], v10 offset:6144
    ds_read_b64_tr_b16 v[202:203], v10 offset:6656
    v_mfma_f32_32x32x16_bf16 v[176:191], v[212:215], v[68:71], v[176:191]
    ds_read_b64_tr_b16 v[204:205], v11 offset:6144
    ds_read_b64_tr_b16 v[206:207], v11 offset:6656
    s_waitcnt lgkmcnt(4)
    v_mfma_f32_32x32x16_bf16 v[160:175], v[192:195], v[72:75], v[160:175]
    ds_read_b64_tr_b16 v[208:209], v10 offset:16384
    ds_read_b64_tr_b16 v[210:211], v10 offset:16896
    v_mfma_f32_32x32x16_bf16 v[176:191], v[196:199], v[72:75], v[176:191]
    ds_read_b64_tr_b16 v[212:213], v11 offset:16384
    ds_read_b64_tr_b16 v[214:215], v11 offset:16896
    s_cmp_lg_u32 s72, 0
    s_cbranch_scc1 L_d49
    s_add_u32 m0, s59, 65536
    s_add_u32 s60, s60, 229376
    buffer_load_dwordx4 v4, s[28:31], s60 offen lds
L_d49:
    s_waitcnt lgkmcnt(4)
    v_mfma_f32_32x32x16_bf16 v[160:175], v[200:203], v[76:79], v[160:175]
    ds_read_b64_tr_b16 v[192:193], v10 offset:18432
    ds_read_b64_tr_b16 v[194:195], v10 offset:18944
    v_mfma_f32_32x32x16_bf16 v[176:191], v[204:207], v[76:79], v[176:191]
    ds_read_b64_tr_b16 v[196:197], v11 offset:18432
    ds_read_b64_tr_b16 v[198:199], v11 offset:18944
    s_cmp_lg_u32 s72, 0
    s_cbranch_scc1 L_d50
    s_add_u32 m0, s59, 73728
    s_nop 0
    buffer_load_dwordx4 v250, s[32:35], s60 offen lds
L_d50:
    s_waitcnt lgkmcnt(4)
    v_mfma_f32_32x32x16_bf16 v[160:175], v[208:211], v[80:83], v[160:175]
    ds_read_b64_tr_b16 v[200:201], v10 offset:20480
    ds_read_b64_tr_b16 v[202:203], v10 offset:20992
    v_mfma_f32_32x32x16_bf16 v[176:191], v[212:215], v[80:83], v[176:191]
    ds_read_b64_tr_b16 v[204:205], v11 offset:20480
    ds_read_b64_tr_b16 v[206:207], v11 offset:20992
    s_cmp_lg_u32 s72, 2
    s_cbranch_scc1 L_d51
    s_add_u32 m0, s59, 65536
    s_add_u32 s60, s60, 229376
    buffer_load_dwordx4 v4, s[28:31], s60 offen lds
L_d51:
    s_waitcnt lgkmcnt(4)
    v_mfma_f32_32x32x16_bf16 v[160:175], v[192:195], v[84:87], v[160:175]
    ds_read_b64_tr_b16 v[208:209], v10 offset:22528
    ds_read_b64_tr_b16 v[210:211], v10 offset:23040
    v_mfma_f32_32x32x16_bf16 v[176:191], v[196:199], v[84:87], v[176:191]
    ds_read_b64_tr_b16 v[212:213], v11 offset:22528
    ds_read_b64_tr_b16 v[214:215], v11 offset:23040
    s_cmp_lg_u32 s72, 2
    s_cbranch_scc1 L_d52
    s_add_u32 m0, s59, 73728
    s_nop 0
    buffer_load_dwordx4 v250, s[32:35], s60 offen lds
L_d52:
    s_waitcnt lgkmcnt(4)
    v_mfma_f32_32x32x16_bf16 v[160:175], v[200:203], v[88:91], v[160:175]
    s_waitcnt vmcnt(6)
    s_barrier
    s_cmp_lg_u32 s48, 0
    s_cbranch_scc1 L_q53
    v_readfirstlane_b32 s68, v238
    s_nop 0
    s_cmp_lg_u32 s68, 0
    s_cbranch_scc1 L_fl54
    s_mov_b32 s69, 0x40000
L_fs55:
    v_mov_b32 v253, 0
    global_load_dword v238, v253, s[20:21] sc1
    s_waitcnt vmcnt(0)
    v_readfirstlane_b32 s68, v238
    s_sub_u32 s69, s69, 1
    s_cselect_b32 s68, 1, s68
    s_cmp_eq_u32 s68, 0
    s_cbranch_scc1 L_fs55
L_fl54:
    s_add_u32 s68, s52, 0
    s_lshl_b32 s68, s68, 7
    s_add_u32 s68, s68, 18350080
    v_mov_b32 v253, 0
    v_mov_b32 v254, 1
    s_mov_b64 exec, 1
    buffer_atomic_add v254, v253, s[44:47], s68 offen sc1
    s_mov_b64 exec, -1
L_q53:
    v_add_u32 v10, 0x0, v7
    ds_read_b64_tr_b16 v[192:193], v10 offset:0
    ds_read_b64_tr_b16 v[194:195], v10 offset:512
    v_mfma_f32_32x32x16_bf16 v[176:191], v[204:207], v[88:91], v[176:191]
    v_add_u32 v11, 0x0, v8
    ds_read_b64_tr_b16 v[196:197], v11 offset:0
    ds_read_b64_tr_b16 v[198:199], v11 offset:512
    s_cmp_lg_u32 s72, 0
    s_cbranch_scc1 L_d56
    s_add_u32 m0, s59, 81920
    s_add_u32 s60, s60, 229376
    buffer_load_dwordx4 v4, s[28:31], s60 offen lds
    s_add_u32 m0, s59, 90112
    s_nop 0
    buffer_load_dwordx4 v250, s[32:35], s60 offen lds
    s_add_u32 m0, s59, 98304
    s_add_u32 s60, s60, 229376
    buffer_load_dwordx4 v4, s[28:31], s60 offen lds
    s_add_u32 m0, s59, 106496
    s_nop 0
    buffer_load_dwordx4 v250, s[32:35], s60 offen lds
L_d56:
    s_waitcnt lgkmcnt(4)
    v_mfma_f32_32x32x16_bf16 v[160:175], v[208:211], v[92:95], v[160:175]
    ds_read_b64_tr_b16 v[200:201], v10 offset:2048
    ds_read_b64_tr_b16 v[202:203], v10 offset:2560
    v_mfma_f32_32x32x16_bf16 v[176:191], v[212:215], v[92:95], v[176:191]
    ds_read_b64_tr_b16 v[204:205], v11 offset:2048
    ds_read_b64_tr_b16 v[206:207], v11 offset:2560
    s_waitcnt lgkmcnt(4)
    v_mfma_f32_32x32x16_bf16 v[160:175], v[192:195], v[96:99], v[160:175]
    ds_read_b64_tr_b16 v[208:209], v10 offset:4096
    ds_read_b64_tr_b16 v[210:211], v10 offset:4608
    v_mfma_f32_32x32x16_bf16 v[176:191], v[196:199], v[96:99], v[176:191]
    ds_read_b64_tr_b16 v[212:213], v11 offset:4096
    ds_read_b64_tr_b16 v[214:215], v11 offset:4608
    s_cmp_lg_u32 s72, 2
    s_cbranch_scc1 L_d57
    s_add_u32 m0, s59, 81920
    s_add_u32 s60, s60, 229376
    buffer_load_dwordx4 v4, s[28:31], s60 offen lds
    s_add_u32 m0, s59, 90112
    s_nop 0
    buffer_load_dwordx4 v250, s[32:35], s60 offen lds
    s_add_u32 m0, s59, 98304
    s_add_u32 s60, s60, 229376
    buffer_load_dwordx4 v4, s[28:31], s60 offen lds
    s_add_u32 m0, s59, 106496
    s_nop 0
    buffer_load_dwordx4 v250, s[32:35], s60 offen lds
L_d57:
    s_waitcnt lgkmcnt(4)
    v_mfma_f32_32x32x16_bf16 v[160:175], v[200:203], v[100:103], v[160:175]
    ds_read_b64_tr_b16 v[192:193], v10 offset:6144
    ds_read_b64_tr_b16 v[194:195], v10 offset:6656
    v_mfma_f32_32x32x16_bf16 v[176:191], v[204:207], v[100:103], v[176:191]
    ds_read_b64_tr_b16 v[196:197], v11 offset:6144
    ds_read_b64_tr_b16 v[198:199], v11 offset:6656
    s_waitcnt lgkmcnt(4)
    v_mfma_f32_32x32x16_bf16 v[160:175], v[208:211], v[104:107], v[160:175]
    ds_read_b64_tr_b16 v[200:201], v10 offset:16384
    ds_read_b64_tr_b16 v[202:203], v10 offset:16896
    v_mfma_f32_32x32x16_bf16 v[176:191], v[212:215], v[104:107], v[176:191]
    ds_read_b64_tr_b16 v[204:205], v11 offset:16384
    ds_read_b64_tr_b16 v[206:207], v11 offset:16896
    s_cmp_lg_u32 s72, 0
    s_cbranch_scc1 L_d58
    s_add_u32 m0, s59, 131072
    s_add_u32 s60, s60, 229376
    buffer_load_dwordx4 v4, s[28:31], s60 offen lds
L_d58:
    s_waitcnt lgkmcnt(4)
    v_mfma_f32_32x32x16_bf16 v[160:175], v[192:195], v[108:111], v[160:175]
    ds_read_b64_tr_b16 v[208:209], v10 offset:18432
    ds_read_b64_tr_b16 v[210:211], v10 offset:18944
    v_mfma_f32_32x32x16_bf16 v[176:191], v[196:199], v[108:111], v[176:191]
    ds_read_b64_tr_b16 v[212:213], v11 offset:18432
    ds_read_b64_tr_b16 v[214:215], v11 offset:18944
    s_cmp_lg_u32 s72, 0
    s_cbranch_scc1 L_d59
    s_add_u32 m0, s59, 139264
    s_nop 0
    buffer_load_dwordx4 v250, s[32:35], s60 offen lds
L_d59:
    s_waitcnt lgkmcnt(4)
    v_mfma_f32_32x32x16_bf16 v[160:175], v[200:203], v[112:115], v[160:175]
    ds_read_b64_tr_b16 v[192:193], v10 offset:20480
    ds_read_b64_tr_b16 v[194:195], v10 offset:20992
    v_mfma_f32_32x32x16_bf16 v[176:191], v[204:207], v[112:115], v[176:191]
    ds_read_b64_tr_b16 v[196:197], v11 offset:20480
    ds_read_b64_tr_b16 v[198:199], v11 offset:20992
    s_cmp_lg_u32 s72, 2
    s_cbranch_scc1 L_d60
    s_add_u32 m0, s59, 131072
    s_add_u32 s60, s60, 229376
    buffer_load_dwordx4 v4, s[28:31], s60 offen lds
L_d60:
    s_waitcnt lgkmcnt(4)
    v_mfma_f32_32x32x16_bf16 v[160:175], v[208:211], v[116:119], v[160:175]
    ds_read_b64_tr_b16 v[200:201], v10 offset:22528
    ds_read_b64_tr_b16 v[202:203], v10 offset:23040
    v_mfma_f32_32x32x16_bf16 v[176:191], v[212:215], v[116:119], v[176:191]
    ds_read_b64_tr_b16 v[204:205], v11 offset:22528
    ds_read_b64_tr_b16 v[206:207], v11 offset:23040
    s_cmp_lg_u32 s72, 2
    s_cbranch_scc1 L_d61
    s_add_u32 m0, s59, 139264
    s_nop 0
    buffer_load_dwordx4 v250, s[32:35], s60 offen lds
L_d61:
    s_waitcnt lgkmcnt(4)
    v_mfma_f32_32x32x16_bf16 v[160:175], v[192:195], v[120:123], v[160:175]
    s_waitcnt vmcnt(8)
    s_barrier
    v_lshrrev_b32 v253, 2, v2
    v_add_u32 v253, 163584, v253
    v_mov_b32 v254, 0
    ds_write_b32 v253, v254
    v_add_u32 v10, 0x0, v9
    ds_read_b64_tr_b16 v[208:209], v10 offset:32768
    ds_read_b64_tr_b16 v[210:211], v10 offset:33280
    v_mfma_f32_32x32x16_bf16 v[176:191], v[196:199], v[120:123], v[176:191]
    v_add_u32 v11, 0x0, v243
    ds_read_b64_tr_b16 v[212:213], v11 offset:32768
    ds_read_b64_tr_b16 v[214:215], v11 offset:33280
    s_cmp_lg_u32 s72, 0
    s_cbranch_scc1 L_d62
    s_add_u32 m0, s59, 114688
    s_add_u32 s60, s60, 229376
    buffer_load_dwordx4 v4, s[28:31], s60 offen lds
    s_add_u32 m0, s59, 122880
    s_nop 0
    buffer_load_dwordx4 v250, s[32:35], s60 offen lds
L_d62:
    s_waitcnt lgkmcnt(5)
    v_mfma_f32_32x32x16_bf16 v[160:175], v[200:203], v[124:127], v[160:175]
    ds_read_b64_tr_b16 v[192:193], v10 offset:34816
    ds_read_b64_tr_b16 v[194:195], v10 offset:35328
    v_mfma_f32_32x32x16_bf16 v[176:191], v[204:207], v[124:127], v[176:191]
    ds_read_b64_tr_b16 v[196:197], v11 offset:34816
    ds_read_b64_tr_b16 v[198:199], v11 offset:35328
    s_branch L_r2
L_pv:
    s_waitcnt lgkmcnt(4)
    v_mfma_f32_32x32x16_bf16 v[160:175], v[200:203], v[16:19], 0
    ds_read_b64_tr_b16 v[192:193], v10 offset:4096
    ds_read_b64_tr_b16 v[194:195], v10 offset:4608
    v_mfma_f32_32x32x16_bf16 v[176:191], v[204:207], v[16:19], 0
    ds_read_b64_tr_b16 v[196:197], v11 offset:4096
    ds_read_b64_tr_b16 v[198:199], v11 offset:4608
    s_cmp_lg_u32 s72, 2
    s_cbranch_scc1 L_d63
    s_add_u32 m0, s59, 0
    s_add_u32 s60, s60, 229376
    buffer_load_dwordx4 v4, s[28:31], s60 offen lds
L_d63:
    s_waitcnt lgkmcnt(4)
    v_mfma_f32_32x32x16_bf16 v[160:175], v[208:211], v[20:23], v[160:175]
    ds_read_b64_tr_b16 v[200:201], v10 offset:6144
    ds_read_b64_tr_b16 v[202:203], v10 offset:6656
    v_mfma_f32_32x32x16_bf16 v[176:191], v[212:215], v[20:23], v[176:191]
    ds_read_b64_tr_b16 v[204:205], v11 offset:6144
    ds_read_b64_tr_b16 v[206:207], v11 offset:6656
    s_cmp_lg_u32 s72, 2
    s_cbranch_scc1 L_d64
    s_add_u32 m0, s59, 8192
    s_nop 0
    buffer_load_dwordx4 v4, s[32:35], s60 offen lds
L_d64:
    s_waitcnt vmcnt(4)
    v_rsq_f32 v234, v232
    s_waitcnt lgkmcnt(4)
    v_mfma_f32_32x32x16_bf16 v[160:175], v[192:195], v[24:27], v[160:175]
    s_waitcnt vmcnt(6)
    s_barrier
    v_mov_b32 v238, 0
    global_load_dword v238, v238, s[20:21] sc1
    ds_read_b64_tr_b16 v[208:209], v10 offset:16384
    ds_read_b64_tr_b16 v[210:211], v10 offset:16896
    v_mul_f32 v233, 0xbfb8aa3b, v234
    s_cmp_lt_u32 s52, 4
    s_cselect_b32 s68, 0x3e8b97f6, 1.0
    v_mul_f32 v234, s68, v234
    v_mul_f32 v128, v234, v128
    v_mul_f32 v129, v234, v129
    v_mul_f32 v130, v234, v130
    v_mul_f32 v131, v234, v131
    v_cvt_pk_bf16_f32 v224, v128, v129
    v_mfma_f32_32x32x16_bf16 v[176:191], v[196:199], v[24:27], v[176:191]
    ds_read_b64_tr_b16 v[212:213], v11 offset:16384
    ds_read_b64_tr_b16 v[214:215], v11 offset:16896
    s_cmp_lg_u32 s72, 0
    s_cbranch_scc1 L_d65
    s_add_u32 m0, s59, 16384
    s_add_u32 s60, s60, 229376
    buffer_load_dwordx4 v4, s[28:31], s60 offen lds
L_d65:
    v_cvt_pk_bf16_f32 v225, v130, v131
    v_mul_f32 v132, v234, v132
    s_waitcnt lgkmcnt(4)
    v_mfma_f32_32x32x16_bf16 v[160:175], v[200:203], v[28:31], v[160:175]
    ds_read_b64_tr_b16 v[192:193], v10 offset:18432
    ds_read_b64_tr_b16 v[194:195], v10 offset:18944
    v_mul_f32 v133, v234, v133
    v_mul_f32 v134, v234, v134
    v_mul_f32 v135, v234, v135
    v_cvt_pk_bf16_f32 v226, v132, v133
    v_cvt_pk_bf16_f32 v227, v134, v135
    v_mul_f32 v136, v234, v136
    v_mul_f32 v137, v234, v137
    v_mul_f32 v138, v234, v138
    v_mfma_f32_32x32x16_bf16 v[176:191], v[204:207], v[28:31], v[176:191]
    ds_read_b64_tr_b16 v[196:197], v11 offset:18432
    ds_read_b64_tr_b16 v[198:199], v11 offset:18944
    s_cmp_lg_u32 s72, 0
    s_cbranch_scc1 L_d66
    s_add_u32 m0, s59, 24576
    s_nop 0
    buffer_load_dwordx4 v4, s[32:35], s60 offen lds
L_d66:
    v_mul_f32 v139, v234, v139
    v_cvt_pk_bf16_f32 v228, v136, v137
    s_waitcnt lgkmcnt(4)
    v_mfma_f32_32x32x16_bf16 v[160:175], v[208:211], v[32:35], v[160:175]
    ds_read_b64_tr_b16 v[200:201], v10 offset:20480
    ds_read_b64_tr_b16 v[202:203], v10 offset:20992
    v_cvt_pk_bf16_f32 v229, v138, v139
    v_mul_f32 v140, v234, v140
    v_mul_f32 v141, v234, v141
    v_mul_f32 v142, v234, v142
    v_mul_f32 v143, v234, v143
    v_cvt_pk_bf16_f32 v230, v140, v141
    v_cvt_pk_bf16_f32 v231, v142, v143
    v_cndmask_b32 v230, v236, v230, vcc
    v_mfma_f32_32x32x16_bf16 v[176:191], v[212:215], v[32:35], v[176:191]
    ds_read_b64_tr_b16 v[204:205], v11 offset:20480
    ds_read_b64_tr_b16 v[206:207], v11 offset:20992
    s_cmp_lg_u32 s72, 2
    s_cbranch_scc1 L_d67
    s_add_u32 m0, s59, 16384
    s_add_u32 s60, s60, 229376
    buffer_load_dwordx4 v4, s[28:31], s60 offen lds
L_d67:
    v_cndmask_b32 v231, v237, v231, vcc
    ds_write_b64 v248, v[224:225]
    s_waitcnt lgkmcnt(5)
    v_mfma_f32_32x32x16_bf16 v[160:175], v[192:195], v[36:39], v[160:175]
    ds_read_b64_tr_b16 v[208:209], v10 offset:22528
    ds_read_b64_tr_b16 v[210:211], v10 offset:23040
    v_xor_b32 v235, 16, v248
    ds_write_b64 v235, v[226:227]
    v_xor_b32 v235, 32, v248
    ds_write_b64 v235, v[228:229]
    v_xor_b32 v235, 48, v248
    ds_write_b64 v235, v[230:231]
    v_mfma_f32_32x32x16_bf16 v[176:191], v[196:199], v[36:39], v[176:191]
    ds_read_b64_tr_b16 v[212:213], v11 offset:22528
    ds_read_b64_tr_b16 v[214:215], v11 offset:23040
    s_cmp_lg_u32 s72, 2
    s_cbranch_scc1 L_d68
    s_add_u32 m0, s59, 24576
    s_nop 0
    buffer_load_dwordx4 v4, s[32:35], s60 offen lds
L_d68:
    s_waitcnt lgkmcnt(2)
    v_mfma_f32_32x32x16_bf16 v[160:175], v[200:203], v[40:43], v[160:175]
    ds_read_b64_tr_b16 v[192:193], v10 offset:32768
    ds_read_b64_tr_b16 v[194:195], v10 offset:33280
    ds_read_b64_tr_b16 v[128:129], v249 offset:0
    ds_read_b64_tr_b16 v[130:131], v239 offset:512
    ds_read_b64_tr_b16 v[132:133], v249 offset:1024
    ds_read_b64_tr_b16 v[134:135], v239 offset:1536
    s_waitcnt lgkmcnt(0)
    v_mfma_f32_32x32x16_bf16 v[176:191], v[204:207], v[40:43], v[176:191]
    ds_read_b64_tr_b16 v[196:197], v11 offset:32768
    ds_read_b64_tr_b16 v[198:199], v11 offset:33280
    buffer_store_dwordx4 v[128:131], v2, s[44:47], s66 offen offset:0 sc1
    buffer_store_dwordx4 v[132:135], v2, s[44:47], s66 offen offset:1024 sc1
    s_add_u32 s66, s66, 131072
    v_mul_f32 v144, v234, v144
    v_mul_f32 v145, v234, v145
    v_mul_f32 v146, v234, v146
    v_mfma_f32_32x32x16_bf16 v[160:175], v[208:211], v[44:47], v[160:175]
    ds_read_b64_tr_b16 v[200:201], v10 offset:34816
    ds_read_b64_tr_b16 v[202:203], v10 offset:35328
    v_mul_f32 v147, v234, v147
    v_cvt_pk_bf16_f32 v224, v144, v145
    v_cvt_pk_bf16_f32 v225, v146, v147
    v_mul_f32 v148, v234, v148
    v_mul_f32 v149, v234, v149
    v_mul_f32 v150, v234, v150
    v_mul_f32 v151, v234, v151
    v_cvt_pk_bf16_f32 v226, v148, v149
    v_mfma_f32_32x32x16_bf16 v[176:191], v[212:215], v[44:47], v[176:191]
    ds_read_b64_tr_b16 v[204:205], v11 offset:34816
    ds_read_b64_tr_b16 v[206:207], v11 offset:35328
    v_cvt_pk_bf16_f32 v227, v150, v151
    v_mul_f32 v152, v234, v152
    v_mul_f32 v153, v234, v153
    v_mul_f32 v154, v234, v154
    v_mul_f32 v155, v234, v155
    v_cvt_pk_bf16_f32 v228, v152, v153
    v_cvt_pk_bf16_f32 v229, v154, v155
    v_mul_f32 v156, v234, v156
    s_waitcnt lgkmcnt(4)
    v_mfma_f32_32x32x16_bf16 v[160:175], v[192:195], v[48:51], v[160:175]
    ds_read_b64_tr_b16 v[208:209], v10 offset:36864
    ds_read_b64_tr_b16 v[210:211], v10 offset:37376
    v_mul_f32 v157, v234, v157
    v_mul_f32 v158, v234, v158
    v_mul_f32 v159, v234, v159
    v_cvt_pk_bf16_f32 v230, v156, v157
    v_cvt_pk_bf16_f32 v231, v158, v159
    v_cndmask_b32 v230, v236, v230, vcc
    v_cndmask_b32 v231, v237, v231, vcc
    ds_write_b64 v248, v[224:225]
    v_mfma_f32_32x32x16_bf16 v[176:191], v[196:199], v[48:51], v[176:191]
    ds_read_b64_tr_b16 v[212:213], v11 offset:36864
    ds_read_b64_tr_b16 v[214:215], v11 offset:37376
    v_xor_b32 v235, 16, v248
    ds_write_b64 v235, v[226:227]
    v_xor_b32 v235, 32, v248
    ds_write_b64 v235, v[228:229]
    v_xor_b32 v235, 48, v248
    ds_write_b64 v235, v[230:231]
    s_waitcnt lgkmcnt(8)
    v_mfma_f32_32x32x16_bf16 v[160:175], v[200:203], v[52:55], v[160:175]
    ds_read_b64_tr_b16 v[192:193], v10 offset:38912
    ds_read_b64_tr_b16 v[194:195], v10 offset:39424
    s_waitcnt lgkmcnt(2)
    ds_read_b64_tr_b16 v[144:145], v249 offset:0
    ds_read_b64_tr_b16 v[146:147], v239 offset:512
    ds_read_b64_tr_b16 v[148:149], v249 offset:1024
    ds_read_b64_tr_b16 v[150:151], v239 offset:1536
    v_mfma_f32_32x32x16_bf16 v[176:191], v[204:207], v[52:55], v[176:191]
    ds_read_b64_tr_b16 v[196:197], v11 offset:38912
    ds_read_b64_tr_b16 v[198:199], v11 offset:39424
    s_waitcnt lgkmcnt(2)
    buffer_store_dwordx4 v[144:147], v2, s[44:47], s66 offen offset:0 sc1
    buffer_store_dwordx4 v[148:151], v2, s[44:47], s66 offen offset:1024 sc1
    s_add_u32 s66, s66, 131072
    v_mfma_f32_32x32x16_bf16 v[160:175], v[208:211], v[56:59], v[160:175]
    s_waitcnt vmcnt(9)
    s_barrier
    v_add_u32 v10, 0x20000, v7
    ds_read_b64_tr_b16 v[200:201], v10 offset:0
    ds_read_b64_tr_b16 v[202:203], v10 offset:512
    v_mfma_f32_32x32x16_bf16 v[176:191], v[212:215], v[56:59], v[176:191]
    v_add_u32 v11, 0x20000, v8
    ds_read_b64_tr_b16 v[204:205], v11 offset:0
    ds_read_b64_tr_b16 v[206:207], v11 offset:512
    s_cmp_lg_u32 s72, 0
    s_cbranch_scc1 L_d69
    s_mov_b32 s60, s57
    s_add_u32 m0, s59, 32768
    s_nop 0
    buffer_load_dwordx4 v4, s[28:31], s60 offen lds
    s_add_u32 m0, s59, 40960
    s_nop 0
    buffer_load_dwordx4 v250, s[32:35], s60 offen lds
    s_add_u32 m0, s59, 49152
    s_add_u32 s60, s60, 229376
    buffer_load_dwordx4 v4, s[28:31], s60 offen lds
    s_add_u32 m0, s59, 57344
    s_nop 0
    buffer_load_dwordx4 v250, s[32:35], s60 offen lds
L_d69:
    s_waitcnt lgkmcnt(4)
    v_mfma_f32_32x32x16_bf16 v[160:175], v[192:195], v[60:63], v[160:175]
    ds_read_b64_tr_b16 v[208:209], v10 offset:2048
    ds_read_b64_tr_b16 v[210:211], v10 offset:2560
    v_mfma_f32_32x32x16_bf16 v[176:191], v[196:199], v[60:63], v[176:191]
    ds_read_b64_tr_b16 v[212:213], v11 offset:2048
    ds_read_b64_tr_b16 v[214:215], v11 offset:2560
    s_waitcnt lgkmcnt(4)
    v_mfma_f32_32x32x16_bf16 v[160:175], v[200:203], v[64:67], v[160:175]
    ds_read_b64_tr_b16 v[192:193], v10 offset:4096
    ds_read_b64_tr_b16 v[194:195], v10 offset:4608
    v_mfma_f32_32x32x16_bf16 v[176:191], v[204:207], v[64:67], v[176:191]
    ds_read_b64_tr_b16 v[196:197], v11 offset:4096
    ds_read_b64_tr_b16 v[198:199], v11 offset:4608
    s_cmp_lg_u32 s72, 2
    s_cbranch_scc1 L_d70
    s_mov_b32 s60, s57
    s_add_u32 m0, s59, 32768
    s_nop 0
    buffer_load_dwordx4 v4, s[28:31], s60 offen lds
    s_add_u32 m0, s59, 40960
    s_nop 0
    buffer_load_dwordx4 v250, s[32:35], s60 offen lds
    s_add_u32 m0, s59, 49152
    s_add_u32 s60, s60, 229376
    buffer_load_dwordx4 v4, s[28:31], s60 offen lds
    s_add_u32 m0, s59, 57344
    s_nop 0
    buffer_load_dwordx4 v250, s[32:35], s60 offen lds
L_d70:
    s_waitcnt lgkmcnt(4)
    v_mfma_f32_32x32x16_bf16 v[160:175], v[208:211], v[68:71], v[160:175]
    ds_read_b64_tr_b16 v[200:201], v10 offset:6144
    ds_read_b64_tr_b16 v[202:203], v10 offset:6656
    v_mfma_f32_32x32x16_bf16 v[176:191], v[212:215], v[68:71], v[176:191]
    ds_read_b64_tr_b16 v[204:205], v11 offset:6144
    ds_read_b64_tr_b16 v[206:207], v11 offset:6656
    s_waitcnt lgkmcnt(4)
    v_mfma_f32_32x32x16_bf16 v[160:175], v[192:195], v[72:75], v[160:175]
    ds_read_b64_tr_b16 v[208:209], v10 offset:16384
    ds_read_b64_tr_b16 v[210:211], v10 offset:16896
    v_mfma_f32_32x32x16_bf16 v[176:191], v[196:199], v[72:75], v[176:191]
    ds_read_b64_tr_b16 v[212:213], v11 offset:16384
    ds_read_b64_tr_b16 v[214:215], v11 offset:16896
    s_cmp_lg_u32 s72, 0
    s_cbranch_scc1 L_d71
    s_add_u32 m0, s59, 65536
    s_add_u32 s60, s60, 229376
    buffer_load_dwordx4 v4, s[28:31], s60 offen lds
L_d71:
    s_waitcnt lgkmcnt(4)
    v_mfma_f32_32x32x16_bf16 v[160:175], v[200:203], v[76:79], v[160:175]
    ds_read_b64_tr_b16 v[192:193], v10 offset:18432
    ds_read_b64_tr_b16 v[194:195], v10 offset:18944
    v_mfma_f32_32x32x16_bf16 v[176:191], v[204:207], v[76:79], v[176:191]
    ds_read_b64_tr_b16 v[196:197], v11 offset:18432
    ds_read_b64_tr_b16 v[198:199], v11 offset:18944
    s_cmp_lg_u32 s72, 0
    s_cbranch_scc1 L_d72
    s_add_u32 m0, s59, 73728
    s_nop 0
    buffer_load_dwordx4 v250, s[32:35], s60 offen lds
L_d72:
    s_waitcnt lgkmcnt(4)
    v_mfma_f32_32x32x16_bf16 v[160:175], v[208:211], v[80:83], v[160:175]
    ds_read_b64_tr_b16 v[200:201], v10 offset:20480
    ds_read_b64_tr_b16 v[202:203], v10 offset:20992
    v_mfma_f32_32x32x16_bf16 v[176:191], v[212:215], v[80:83], v[176:191]
    ds_read_b64_tr_b16 v[204:205], v11 offset:20480
    ds_read_b64_tr_b16 v[206:207], v11 offset:20992
    s_cmp_lg_u32 s72, 2
    s_cbranch_scc1 L_d73
    s_add_u32 m0, s59, 65536
    s_add_u32 s60, s60, 229376
    buffer_load_dwordx4 v4, s[28:31], s60 offen lds
L_d73:
    s_waitcnt lgkmcnt(4)
    v_mfma_f32_32x32x16_bf16 v[160:175], v[192:195], v[84:87], v[160:175]
    ds_read_b64_tr_b16 v[208:209], v10 offset:22528
    ds_read_b64_tr_b16 v[210:211], v10 offset:23040
    v_mfma_f32_32x32x16_bf16 v[176:191], v[196:199], v[84:87], v[176:191]
    ds_read_b64_tr_b16 v[212:213], v11 offset:22528
    ds_read_b64_tr_b16 v[214:215], v11 offset:23040
    s_cmp_lg_u32 s72, 2
    s_cbranch_scc1 L_d74
    s_add_u32 m0, s59, 73728
    s_nop 0
    buffer_load_dwordx4 v250, s[32:35], s60 offen lds
L_d74:
    s_waitcnt lgkmcnt(4)
    v_mfma_f32_32x32x16_bf16 v[160:175], v[200:203], v[88:91], v[160:175]
    s_waitcnt vmcnt(6)
    s_barrier
    s_cmp_lg_u32 s48, 0
    s_cbranch_scc1 L_q75
    v_readfirstlane_b32 s68, v238
    s_nop 0
    s_cmp_lg_u32 s68, 0
    s_cbranch_scc1 L_fl76
    s_mov_b32 s69, 0x40000
L_fs77:
    v_mov_b32 v253, 0
    global_load_dword v238, v253, s[20:21] sc1
    s_waitcnt vmcnt(0)
    v_readfirstlane_b32 s68, v238
    s_sub_u32 s69, s69, 1
    s_cselect_b32 s68, 1, s68
    s_cmp_eq_u32 s68, 0
    s_cbranch_scc1 L_fs77
L_fl76:
    s_add_u32 s68, s52, 0
    s_lshl_b32 s68, s68, 7
    s_add_u32 s68, s68, 18350080
    v_mov_b32 v253, 0
    v_mov_b32 v254, 1
    s_mov_b64 exec, 1
    buffer_atomic_add v254, v253, s[44:47], s68 offen sc1
    s_mov_b64 exec, -1
L_q75:
    v_add_u32 v10, 0x0, v7
    ds_read_b64_tr_b16 v[192:193], v10 offset:0
    ds_read_b64_tr_b16 v[194:195], v10 offset:512
    v_mfma_f32_32x32x16_bf16 v[176:191], v[204:207], v[88:91], v[176:191]
    v_add_u32 v11, 0x0, v8
    ds_read_b64_tr_b16 v[196:197], v11 offset:0
    ds_read_b64_tr_b16 v[198:199], v11 offset:512
    s_cmp_lg_u32 s72, 0
    s_cbranch_scc1 L_d78
    s_add_u32 m0, s59, 81920
    s_add_u32 s60, s60, 229376
    buffer_load_dwordx4 v4, s[28:31], s60 offen lds
    s_add_u32 m0, s59, 90112
    s_nop 0
    buffer_load_dwordx4 v250, s[32:35], s60 offen lds
    s_add_u32 m0, s59, 98304
    s_add_u32 s60, s60, 229376
    buffer_load_dwordx4 v4, s[28:31], s60 offen lds
    s_add_u32 m0, s59, 106496
    s_nop 0
    buffer_load_dwordx4 v250, s[32:35], s60 offen lds
L_d78:
    s_waitcnt lgkmcnt(4)
    v_mfma_f32_32x32x16_bf16 v[160:175], v[208:211], v[92:95], v[160:175]
    ds_read_b64_tr_b16 v[200:201], v10 offset:2048
    ds_read_b64_tr_b16 v[202:203], v10 offset:2560
    v_mfma_f32_32x32x16_bf16 v[176:191], v[212:215], v[92:95], v[176:191]
    ds_read_b64_tr_b16 v[204:205], v11 offset:2048
    ds_read_b64_tr_b16 v[206:207], v11 offset:2560
    s_waitcnt lgkmcnt(4)
    v_mfma_f32_32x32x16_bf16 v[160:175], v[192:195], v[96:99], v[160:175]
    ds_read_b64_tr_b16 v[208:209], v10 offset:4096
    ds_read_b64_tr_b16 v[210:211], v10 offset:4608
    v_mfma_f32_32x32x16_bf16 v[176:191], v[196:199], v[96:99], v[176:191]
    ds_read_b64_tr_b16 v[212:213], v11 offset:4096
    ds_read_b64_tr_b16 v[214:215], v11 offset:4608
    s_cmp_lg_u32 s72, 2
    s_cbranch_scc1 L_d79
    s_add_u32 m0, s59, 81920
    s_add_u32 s60, s60, 229376
    buffer_load_dwordx4 v4, s[28:31], s60 offen lds
    s_add_u32 m0, s59, 90112
    s_nop 0
    buffer_load_dwordx4 v250, s[32:35], s60 offen lds
    s_add_u32 m0, s59, 98304
    s_add_u32 s60, s60, 229376
    buffer_load_dwordx4 v4, s[28:31], s60 offen lds
    s_add_u32 m0, s59, 106496
    s_nop 0
    buffer_load_dwordx4 v250, s[32:35], s60 offen lds
L_d79:
    s_waitcnt lgkmcnt(4)
    v_mfma_f32_32x32x16_bf16 v[160:175], v[200:203], v[100:103], v[160:175]
    ds_read_b64_tr_b16 v[192:193], v10 offset:6144
    ds_read_b64_tr_b16 v[194:195], v10 offset:6656
    v_mfma_f32_32x32x16_bf16 v[176:191], v[204:207], v[100:103], v[176:191]
    ds_read_b64_tr_b16 v[196:197], v11 offset:6144
    ds_read_b64_tr_b16 v[198:199], v11 offset:6656
    s_waitcnt lgkmcnt(4)
    v_mfma_f32_32x32x16_bf16 v[160:175], v[208:211], v[104:107], v[160:175]
    ds_read_b64_tr_b16 v[200:201], v10 offset:16384
    ds_read_b64_tr_b16 v[202:203], v10 offset:16896
    v_mfma_f32_32x32x16_bf16 v[176:191], v[212:215], v[104:107], v[176:191]
    ds_read_b64_tr_b16 v[204:205], v11 offset:16384
    ds_read_b64_tr_b16 v[206:207], v11 offset:16896
    s_cmp_lg_u32 s72, 0
    s_cbranch_scc1 L_d80
    s_add_u32 m0, s59, 131072
    s_add_u32 s60, s60, 229376
    buffer_load_dwordx4 v4, s[28:31], s60 offen lds
L_d80:
    s_waitcnt lgkmcnt(4)
    v_mfma_f32_32x32x16_bf16 v[160:175], v[192:195], v[108:111], v[160:175]
    ds_read_b64_tr_b16 v[208:209], v10 offset:18432
    ds_read_b64_tr_b16 v[210:211], v10 offset:18944
    v_mfma_f32_32x32x16_bf16 v[176:191], v[196:199], v[108:111], v[176:191]
    ds_read_b64_tr_b16 v[212:213], v11 offset:18432
    ds_read_b64_tr_b16 v[214:215], v11 offset:18944
    s_cmp_lg_u32 s72, 0
    s_cbranch_scc1 L_d81
    s_add_u32 m0, s59, 139264
    s_nop 0
    buffer_load_dwordx4 v250, s[32:35], s60 offen lds
L_d81:
    s_waitcnt lgkmcnt(4)
    v_mfma_f32_32x32x16_bf16 v[160:175], v[200:203], v[112:115], v[160:175]
    ds_read_b64_tr_b16 v[192:193], v10 offset:20480
    ds_read_b64_tr_b16 v[194:195], v10 offset:20992
    v_mfma_f32_32x32x16_bf16 v[176:191], v[204:207], v[112:115], v[176:191]
    ds_read_b64_tr_b16 v[196:197], v11 offset:20480
    ds_read_b64_tr_b16 v[198:199], v11 offset:20992
    s_cmp_lg_u32 s72, 2
    s_cbranch_scc1 L_d82
    s_add_u32 m0, s59, 131072
    s_add_u32 s60, s60, 229376
    buffer_load_dwordx4 v4, s[28:31], s60 offen lds
L_d82:
    s_waitcnt lgkmcnt(4)
    v_mfma_f32_32x32x16_bf16 v[160:175], v[208:211], v[116:119], v[160:175]
    ds_read_b64_tr_b16 v[200:201], v10 offset:22528
    ds_read_b64_tr_b16 v[202:203], v10 offset:23040
    v_mfma_f32_32x32x16_bf16 v[176:191], v[212:215], v[116:119], v[176:191]
    ds_read_b64_tr_b16 v[204:205], v11 offset:22528
    ds_read_b64_tr_b16 v[206:207], v11 offset:23040
    s_cmp_lg_u32 s72, 2
    s_cbranch_scc1 L_d83
    s_add_u32 m0, s59, 139264
    s_nop 0
    buffer_load_dwordx4 v250, s[32:35], s60 offen lds
L_d83:
    s_waitcnt lgkmcnt(4)
    v_mfma_f32_32x32x16_bf16 v[160:175], v[192:195], v[120:123], v[160:175]
    s_waitcnt vmcnt(8)
    s_barrier
    v_lshrrev_b32 v253, 2, v2
    v_add_u32 v253, 163584, v253
    v_mov_b32 v254, 0
    ds_write_b32 v253, v254
    v_add_u32 v10, 0x0, v9
    ds_read_b64_tr_b16 v[208:209], v10 offset:32768
    ds_read_b64_tr_b16 v[210:211], v10 offset:33280
    v_mfma_f32_32x32x16_bf16 v[176:191], v[196:199], v[120:123], v[176:191]
    v_add_u32 v11, 0x0, v243
    ds_read_b64_tr_b16 v[212:213], v11 offset:32768
    ds_read_b64_tr_b16 v[214:215], v11 offset:33280
    s_cmp_lg_u32 s72, 0
    s_cbranch_scc1 L_d84
    s_add_u32 m0, s59, 114688
    s_add_u32 s60, s60, 229376
    buffer_load_dwordx4 v4, s[28:31], s60 offen lds
    s_add_u32 m0, s59, 122880
    s_nop 0
    buffer_load_dwordx4 v250, s[32:35], s60 offen lds
L_d84:
    s_waitcnt lgkmcnt(5)
    v_mfma_f32_32x32x16_bf16 v[160:175], v[200:203], v[124:127], v[160:175]
    ds_read_b64_tr_b16 v[192:193], v10 offset:34816
    ds_read_b64_tr_b16 v[194:195], v10 offset:35328
    v_mfma_f32_32x32x16_bf16 v[176:191], v[204:207], v[124:127], v[176:191]
    ds_read_b64_tr_b16 v[196:197], v11 offset:34816
    ds_read_b64_tr_b16 v[198:199], v11 offset:35328
L_r2:
    s_nop 1
    s_and_b32 s54, s2, 7
    s_lshr_b32 s55, s2, 3
    v_readfirstlane_b32 s68, v238
    s_nop 0
    s_cmp_lg_u32 s68, 0
    s_cbranch_scc1 L_fl85
    s_mov_b32 s69, 0x40000
L_fs86:
    v_mov_b32 v253, 0
    global_load_dword v238, v253, s[20:21] sc1
    s_waitcnt vmcnt(0)
    v_readfirstlane_b32 s68, v238
    s_sub_u32 s69, s69, 1
    s_cselect_b32 s68, 1, s68
    s_cmp_eq_u32 s68, 0
    s_cbranch_scc1 L_fs86
L_fl85:
    s_cmp_lt_u32 s48, 4
    s_cbranch_scc1 L_att
    s_setprio 2
    s_waitcnt lgkmcnt(4)
    v_mfma_f32_32x32x16_bf16 v[128:143], v[208:211], v[16:19], 0
    ds_read_b64_tr_b16 v[200:201], v10 offset:36864
    ds_read_b64_tr_b16 v[202:203], v10 offset:37376
    v_mfma_f32_32x32x16_bf16 v[144:159], v[212:215], v[16:19], 0
    ds_read_b64_tr_b16 v[204:205], v11 offset:36864
    ds_read_b64_tr_b16 v[206:207], v11 offset:37376
    s_cmp_lg_u32 s72, 2
    s_cbranch_scc1 L_d87
    s_add_u32 m0, s59, 114688
    s_add_u32 s60, s60, 229376
    buffer_load_dwordx4 v4, s[28:31], s60 offen lds
    s_add_u32 m0, s59, 122880
    s_nop 0
    buffer_load_dwordx4 v250, s[32:35], s60 offen lds
L_d87:
    s_waitcnt lgkmcnt(4)
    v_mfma_f32_32x32x16_bf16 v[128:143], v[192:195], v[20:23], v[128:143]
    ds_read_b64_tr_b16 v[208:209], v10 offset:38912
    ds_read_b64_tr_b16 v[210:211], v10 offset:39424
    v_mfma_f32_32x32x16_bf16 v[144:159], v[196:199], v[20:23], v[144:159]
    ds_read_b64_tr_b16 v[212:213], v11 offset:38912
    ds_read_b64_tr_b16 v[214:215], v11 offset:39424
    v_mul_f32 v216, v233, v160
    v_mul_f32 v217, v233, v161
    v_mul_f32 v218, v233, v162
    s_waitcnt lgkmcnt(4)
    v_mfma_f32_32x32x16_bf16 v[128:143], v[200:203], v[24:27], v[128:143]
    ds_read_b64_tr_b16 v[192:193], v10 offset:49152
    ds_read_b64_tr_b16 v[194:195], v10 offset:49664
    v_mul_f32 v219, v233, v163
    v_exp_f32 v216, v216
    v_mfma_f32_32x32x16_bf16 v[144:159], v[204:207], v[24:27], v[144:159]
    ds_read_b64_tr_b16 v[196:197], v11 offset:49152
    ds_read_b64_tr_b16 v[198:199], v11 offset:49664
    v_mul_f32 v160, v160, v176
    v_exp_f32 v217, v217
    s_waitcnt lgkmcnt(4)
    v_mfma_f32_32x32x16_bf16 v[128:143], v[208:211], v[28:31], v[128:143]
    ds_read_b64_tr_b16 v[200:201], v10 offset:51200
    ds_read_b64_tr_b16 v[202:203], v10 offset:51712
    v_mul_f32 v161, v161, v177
    v_exp_f32 v218, v218
    v_mfma_f32_32x32x16_bf16 v[144:159], v[212:215], v[28:31], v[144:159]
    ds_read_b64_tr_b16 v[204:205], v11 offset:51200
    ds_read_b64_tr_b16 v[206:207], v11 offset:51712
    v_mul_f32 v162, v162, v178
    v_exp_f32 v219, v219
    s_waitcnt lgkmcnt(4)
    v_mfma_f32_32x32x16_bf16 v[128:143], v[192:195], v[32:35], v[128:143]
    ds_read_b64_tr_b16 v[208:209], v10 offset:53248
    ds_read_b64_tr_b16 v[210:211], v10 offset:53760
    v_mul_f32 v163, v163, v179
    v_fma_f32 v216, v216, v232, v232
    v_fma_f32 v217, v217, v232, v232
    v_mfma_f32_32x32x16_bf16 v[144:159], v[196:199], v[32:35], v[144:159]
    ds_read_b64_tr_b16 v[212:213], v11 offset:53248
    ds_read_b64_tr_b16 v[214:215], v11 offset:53760
    v_fma_f32 v218, v218, v232, v232
    v_fma_f32 v219, v219, v232, v232
    s_waitcnt lgkmcnt(4)
    v_mfma_f32_32x32x16_bf16 v[128:143], v[200:203], v[36:39], v[128:143]
    ds_read_b64_tr_b16 v[192:193], v10 offset:55296
    ds_read_b64_tr_b16 v[194:195], v10 offset:55808
    v_rcp_f32 v216, v216
    v_mfma_f32_32x32x16_bf16 v[144:159], v[204:207], v[36:39], v[144:159]
    ds_read_b64_tr_b16 v[196:197], v11 offset:55296
    ds_read_b64_tr_b16 v[198:199], v11 offset:55808
    v_rcp_f32 v217, v217
    s_waitcnt lgkmcnt(4)
    v_mfma_f32_32x32x16_bf16 v[128:143], v[208:211], v[40:43], v[128:143]
    s_waitcnt vmcnt(0)
    s_barrier
    v_add_u32 v10, 0x10000, v9
    ds_read_b64_tr_b16 v[200:201], v10 offset:0
    ds_read_b64_tr_b16 v[202:203], v10 offset:512
    v_rcp_f32 v218, v218
    v_mfma_f32_32x32x16_bf16 v[144:159], v[212:215], v[40:43], v[144:159]
    v_add_u32 v11, 0x10000, v243
    ds_read_b64_tr_b16 v[204:205], v11 offset:0
    ds_read_b64_tr_b16 v[206:207], v11 offset:512
    v_rcp_f32 v219, v219
    v_mul_f32 v160, v160, v216
    s_waitcnt lgkmcnt(4)
    v_mfma_f32_32x32x16_bf16 v[128:143], v[192:195], v[44:47], v[128:143]
    ds_read_b64_tr_b16 v[208:209], v10 offset:2048
    ds_read_b64_tr_b16 v[210:211], v10 offset:2560
    v_mul_f32 v161, v161, v217
    v_mul_f32 v162, v162, v218
    v_mul_f32 v163, v163, v219
    v_mfma_f32_32x32x16_bf16 v[144:159], v[196:199], v[44:47], v[144:159]
    ds_read_b64_tr_b16 v[212:213], v11 offset:2048
    ds_read_b64_tr_b16 v[214:215], v11 offset:2560
    v_cvt_pk_bf16_f32 v176, v160, v161
    v_cvt_pk_bf16_f32 v177, v162, v163
    v_mul_f32 v220, v233, v164
    s_waitcnt lgkmcnt(4)
    v_mfma_f32_32x32x16_bf16 v[128:143], v[200:203], v[48:51], v[128:143]
    ds_read_b64_tr_b16 v[192:193], v10 offset:4096
    ds_read_b64_tr_b16 v[194:195], v10 offset:4608
    v_mul_f32 v221, v233, v165
    v_mul_f32 v222, v233, v166
    v_mul_f32 v223, v233, v167
    v_mfma_f32_32x32x16_bf16 v[144:159], v[204:207], v[48:51], v[144:159]
    ds_read_b64_tr_b16 v[196:197], v11 offset:4096
    ds_read_b64_tr_b16 v[198:199], v11 offset:4608
    v_exp_f32 v220, v220
    v_mul_f32 v164, v164, v180
    s_waitcnt lgkmcnt(4)
    v_mfma_f32_32x32x16_bf16 v[128:143], v[208:211], v[52:55], v[128:143]
    ds_read_b64_tr_b16 v[200:201], v10 offset:6144
    ds_read_b64_tr_b16 v[202:203], v10 offset:6656
    v_exp_f32 v221, v221
    v_mul_f32 v165, v165, v181
    v_mfma_f32_32x32x16_bf16 v[144:159], v[212:215], v[52:55], v[144:159]
    ds_read_b64_tr_b16 v[204:205], v11 offset:6144
    ds_read_b64_tr_b16 v[206:207], v11 offset:6656
    v_exp_f32 v222, v222
    v_mul_f32 v166, v166, v182
    s_waitcnt lgkmcnt(4)
    v_mfma_f32_32x32x16_bf16 v[128:143], v[192:195], v[56:59], v[128:143]
    ds_read_b64_tr_b16 v[208:209], v10 offset:16384
    ds_read_b64_tr_b16 v[210:211], v10 offset:16896
    v_exp_f32 v223, v223
    v_mul_f32 v167, v167, v183
    v_mfma_f32_32x32x16_bf16 v[144:159], v[196:199], v[56:59], v[144:159]
    ds_read_b64_tr_b16 v[212:213], v11 offset:16384
    ds_read_b64_tr_b16 v[214:215], v11 offset:16896
    v_fma_f32 v220, v220, v232, v232
    v_fma_f32 v221, v221, v232, v232
    v_fma_f32 v222, v222, v232, v232
    s_waitcnt lgkmcnt(4)
    v_mfma_f32_32x32x16_bf16 v[128:143], v[200:203], v[60:63], v[128:143]
    ds_read_b64_tr_b16 v[192:193], v10 offset:18432
    ds_read_b64_tr_b16 v[194:195], v10 offset:18944
    v_fma_f32 v223, v223, v232, v232
    v_rcp_f32 v220, v220
    v_mfma_f32_32x32x16_bf16 v[144:159], v[204:207], v[60:63], v[144:159]
    ds_read_b64_tr_b16 v[196:197], v11 offset:18432
    ds_read_b64_tr_b16 v[198:199], v11 offset:18944
    v_rcp_f32 v221, v221
    s_waitcnt lgkmcnt(4)
    v_mfma_f32_32x32x16_bf16 v[128:143], v[208:211], v[64:67], v[128:143]
    ds_read_b64_tr_b16 v[200:201], v10 offset:20480
    ds_read_b64_tr_b16 v[202:203], v10 offset:20992
    v_rcp_f32 v222, v222
    v_mfma_f32_32x32x16_bf16 v[144:159], v[212:215], v[64:67], v[144:159]
    ds_read_b64_tr_b16 v[204:205], v11 offset:20480
    ds_read_b64_tr_b16 v[206:207], v11 offset:20992
    v_rcp_f32 v223, v223
    v_mul_f32 v164, v164, v220
    s_waitcnt lgkmcnt(4)
    v_mfma_f32_32x32x16_bf16 v[128:143], v[192:195], v[68:71], v[128:143]
    ds_read_b64_tr_b16 v[208:209], v10 offset:22528
    ds_read_b64_tr_b16 v[210:211], v10 offset:23040
    v_mul_f32 v165, v165, v221
    v_mul_f32 v166, v166, v222
    v_mul_f32 v167, v167, v223
    v_mfma_f32_32x32x16_bf16 v[144:159], v[196:199], v[68:71], v[144:159]
    ds_read_b64_tr_b16 v[212:213], v11 offset:22528
    ds_read_b64_tr_b16 v[214:215], v11 offset:23040
    v_cvt_pk_bf16_f32 v178, v164, v165
    v_cvt_pk_bf16_f32 v179, v166, v167
    s_waitcnt lgkmcnt(4)
    v_mfma_f32_32x32x16_bf16 v[128:143], v[200:203], v[72:75], v[128:143]
    ds_read_b64_tr_b16 v[192:193], v10 offset:32768
    ds_read_b64_tr_b16 v[194:195], v10 offset:33280
    buffer_store_dwordx4 v[176:179], v2, s[44:47], s65 offen offset:0 sc1
    v_mul_f32 v216, v233, v168
    v_mfma_f32_32x32x16_bf16 v[144:159], v[204:207], v[72:75], v[144:159]
    ds_read_b64_tr_b16 v[196:197], v11 offset:32768
    ds_read_b64_tr_b16 v[198:199], v11 offset:33280
    v_mul_f32 v217, v233, v169
    v_mul_f32 v218, v233, v170
    v_mul_f32 v219, v233, v171
    s_waitcnt lgkmcnt(4)
    v_mfma_f32_32x32x16_bf16 v[128:143], v[208:211], v[76:79], v[128:143]
    ds_read_b64_tr_b16 v[200:201], v10 offset:34816
    ds_read_b64_tr_b16 v[202:203], v10 offset:35328
    v_exp_f32 v216, v216
    v_mul_f32 v168, v168, v184
    v_mfma_f32_32x32x16_bf16 v[144:159], v[212:215], v[76:79], v[144:159]
    ds_read_b64_tr_b16 v[204:205], v11 offset:34816
    ds_read_b64_tr_b16 v[206:207], v11 offset:35328
    v_exp_f32 v217, v217
    v_mul_f32 v169, v169, v185
    s_waitcnt lgkmcnt(4)
    v_mfma_f32_32x32x16_bf16 v[128:143], v[192:195], v[80:83], v[128:143]
    ds_read_b64_tr_b16 v[208:209], v10 offset:36864
    ds_read_b64_tr_b16 v[210:211], v10 offset:37376
    v_exp_f32 v218, v218
    v_mul_f32 v170, v170, v186
    v_mfma_f32_32x32x16_bf16 v[144:159], v[196:199], v[80:83], v[144:159]
    ds_read_b64_tr_b16 v[212:213], v11 offset:36864
    ds_read_b64_tr_b16 v[214:215], v11 offset:37376
    v_exp_f32 v219, v219
    v_mul_f32 v171, v171, v187
    s_waitcnt lgkmcnt(4)
    v_mfma_f32_32x32x16_bf16 v[128:143], v[200:203], v[84:87], v[128:143]
    ds_read_b64_tr_b16 v[192:193], v10 offset:38912
    ds_read_b64_tr_b16 v[194:195], v10 offset:39424
    v_fma_f32 v216, v216, v232, v232
    v_fma_f32 v217, v217, v232, v232
    v_fma_f32 v218, v218, v232, v232
    v_mfma_f32_32x32x16_bf16 v[144:159], v[204:207], v[84:87], v[144:159]
    ds_read_b64_tr_b16 v[196:197], v11 offset:38912
    ds_read_b64_tr_b16 v[198:199], v11 offset:39424
    v_fma_f32 v219, v219, v232, v232
    v_rcp_f32 v216, v216
    s_waitcnt lgkmcnt(4)
    v_mfma_f32_32x32x16_bf16 v[128:143], v[208:211], v[88:91], v[128:143]
    v_add_u32 v10, 0x20000, v9
    ds_read_b64_tr_b16 v[200:201], v10 offset:0
    ds_read_b64_tr_b16 v[202:203], v10 offset:512
    v_rcp_f32 v217, v217
    v_mfma_f32_32x32x16_bf16 v[144:159], v[212:215], v[88:91], v[144:159]
    v_add_u32 v11, 0x20000, v243
    ds_read_b64_tr_b16 v[204:205], v11 offset:0
    ds_read_b64_tr_b16 v[206:207], v11 offset:512
    v_rcp_f32 v218, v218
    s_waitcnt lgkmcnt(4)
    v_mfma_f32_32x32x16_bf16 v[128:143], v[192:195], v[92:95], v[128:143]
    ds_read_b64_tr_b16 v[208:209], v10 offset:2048
    ds_read_b64_tr_b16 v[210:211], v10 offset:2560
    v_rcp_f32 v219, v219
    v_mul_f32 v168, v168, v216
    v_mfma_f32_32x32x16_bf16 v[144:159], v[196:199], v[92:95], v[144:159]
    ds_read_b64_tr_b16 v[212:213], v11 offset:2048
    ds_read_b64_tr_b16 v[214:215], v11 offset:2560
    v_mul_f32 v169, v169, v217
    v_mul_f32 v170, v170, v218
    v_mul_f32 v171, v171, v219
    s_waitcnt lgkmcnt(4)
    v_mfma_f32_32x32x16_bf16 v[128:143], v[200:203], v[96:99], v[128:143]
    ds_read_b64_tr_b16 v[192:193], v10 offset:4096
    ds_read_b64_tr_b16 v[194:195], v10 offset:4608
    v_cvt_pk_bf16_f32 v184, v168, v169
    v_cvt_pk_bf16_f32 v185, v170, v171
    v_mul_f32 v220, v233, v172
    v_mfma_f32_32x32x16_bf16 v[144:159], v[204:207], v[96:99], v[144:159]
    ds_read_b64_tr_b16 v[196:197], v11 offset:4096
    ds_read_b64_tr_b16 v[198:199], v11 offset:4608
    v_mul_f32 v221, v233, v173
    v_mul_f32 v222, v233, v174
    v_mul_f32 v223, v233, v175
    s_waitcnt lgkmcnt(4)
    v_mfma_f32_32x32x16_bf16 v[128:143], v[208:211], v[100:103], v[128:143]
    ds_read_b64_tr_b16 v[200:201], v10 offset:6144
    ds_read_b64_tr_b16 v[202:203], v10 offset:6656
    v_exp_f32 v220, v220
    v_mul_f32 v172, v172, v188
    v_mfma_f32_32x32x16_bf16 v[144:159], v[212:215], v[100:103], v[144:159]
    ds_read_b64_tr_b16 v[204:205], v11 offset:6144
    ds_read_b64_tr_b16 v[206:207], v11 offset:6656
    v_exp_f32 v221, v221
    v_mul_f32 v173, v173, v189
    s_waitcnt lgkmcnt(4)
    v_mfma_f32_32x32x16_bf16 v[128:143], v[192:195], v[104:107], v[128:143]
    v_add_u32 v10, 0x10000, v9
    ds_read_b64_tr_b16 v[208:209], v10 offset:49152
    ds_read_b64_tr_b16 v[210:211], v10 offset:49664
    v_exp_f32 v222, v222
    v_mul_f32 v174, v174, v190
    v_mfma_f32_32x32x16_bf16 v[144:159], v[196:199], v[104:107], v[144:159]
    v_add_u32 v11, 0x10000, v243
    ds_read_b64_tr_b16 v[212:213], v11 offset:49152
    ds_read_b64_tr_b16 v[214:215], v11 offset:49664
    v_exp_f32 v223, v223
    v_mul_f32 v175, v175, v191
    s_waitcnt lgkmcnt(4)
    v_mfma_f32_32x32x16_bf16 v[128:143], v[200:203], v[108:111], v[128:143]
    ds_read_b64_tr_b16 v[192:193], v10 offset:51200
    ds_read_b64_tr_b16 v[194:195], v10 offset:51712
    v_fma_f32 v220, v220, v232, v232
    v_fma_f32 v221, v221, v232, v232
    v_fma_f32 v222, v222, v232, v232
    v_mfma_f32_32x32x16_bf16 v[144:159], v[204:207], v[108:111], v[144:159]
    ds_read_b64_tr_b16 v[196:197], v11 offset:51200
    ds_read_b64_tr_b16 v[198:199], v11 offset:51712
    v_fma_f32 v223, v223, v232, v232
    v_rcp_f32 v220, v220
    s_waitcnt lgkmcnt(4)
    v_mfma_f32_32x32x16_bf16 v[128:143], v[208:211], v[112:115], v[128:143]
    ds_read_b64_tr_b16 v[200:201], v10 offset:53248
    ds_read_b64_tr_b16 v[202:203], v10 offset:53760
    v_rcp_f32 v221, v221
    v_mfma_f32_32x32x16_bf16 v[144:159], v[212:215], v[112:115], v[144:159]
    ds_read_b64_tr_b16 v[204:205], v11 offset:53248
    ds_read_b64_tr_b16 v[206:207], v11 offset:53760
    v_rcp_f32 v222, v222
    s_waitcnt lgkmcnt(4)
    v_mfma_f32_32x32x16_bf16 v[128:143], v[192:195], v[116:119], v[128:143]
    ds_read_b64_tr_b16 v[208:209], v10 offset:55296
    ds_read_b64_tr_b16 v[210:211], v10 offset:55808
    v_rcp_f32 v223, v223
    v_mul_f32 v172, v172, v220
    v_mfma_f32_32x32x16_bf16 v[144:159], v[196:199], v[116:119], v[144:159]
    ds_read_b64_tr_b16 v[212:213], v11 offset:55296
    ds_read_b64_tr_b16 v[214:215], v11 offset:55808
    v_mul_f32 v173, v173, v221
    v_mul_f32 v174, v174, v222
    v_mul_f32 v175, v175, v223
    s_waitcnt lgkmcnt(4)
    v_mfma_f32_32x32x16_bf16 v[128:143], v[200:203], v[120:123], v[128:143]
    v_cvt_pk_bf16_f32 v186, v172, v173
    v_cvt_pk_bf16_f32 v187, v174, v175
    v_mfma_f32_32x32x16_bf16 v[144:159], v[204:207], v[120:123], v[144:159]
    buffer_store_dwordx4 v[184:187], v2, s[44:47], s65 offen offset:1024 sc1
    s_waitcnt lgkmcnt(0)
    v_mfma_f32_32x32x16_bf16 v[128:143], v[208:211], v[124:127], v[128:143]
    v_mfma_f32_32x32x16_bf16 v[144:159], v[212:215], v[124:127], v[144:159]
    s_nop 10
    v_mul_f32 v216, v233, v128
    v_mul_f32 v217, v233, v129
    v_mul_f32 v218, v233, v130
    v_mul_f32 v219, v233, v131
    v_exp_f32 v216, v216
    v_mul_f32 v128, v128, v136
    v_exp_f32 v217, v217
    v_mul_f32 v129, v129, v137
    v_exp_f32 v218, v218
    v_mul_f32 v130, v130, v138
    v_exp_f32 v219, v219
    v_mul_f32 v131, v131, v139
    v_fma_f32 v216, v216, v232, v232
    v_fma_f32 v217, v217, v232, v232
    v_fma_f32 v218, v218, v232, v232
    v_fma_f32 v219, v219, v232, v232
    v_rcp_f32 v216, v216
    v_rcp_f32 v217, v217
    v_rcp_f32 v218, v218
    v_rcp_f32 v219, v219
    v_mul_f32 v128, v128, v216
    v_mul_f32 v129, v129, v217
    v_mul_f32 v130, v130, v218
    v_mul_f32 v131, v131, v219
    v_cvt_pk_bf16_f32 v224, v128, v129
    v_cvt_pk_bf16_f32 v225, v130, v131
    v_mul_f32 v220, v233, v132
    v_mul_f32 v221, v233, v133
    v_mul_f32 v222, v233, v134
    v_mul_f32 v223, v233, v135
    v_exp_f32 v220, v220
    v_mul_f32 v132, v132, v140
    v_exp_f32 v221, v221
    v_mul_f32 v133, v133, v141
    v_exp_f32 v222, v222
    v_mul_f32 v134, v134, v142
    v_exp_f32 v223, v223
    v_mul_f32 v135, v135, v143
    v_fma_f32 v220, v220, v232, v232
    v_fma_f32 v221, v221, v232, v232
    v_fma_f32 v222, v222, v232, v232
    v_fma_f32 v223, v223, v232, v232
    v_rcp_f32 v220, v220
    v_rcp_f32 v221, v221
    v_rcp_f32 v222, v222
    v_rcp_f32 v223, v223
    v_mul_f32 v132, v132, v220
    v_mul_f32 v133, v133, v221
    v_mul_f32 v134, v134, v222
    v_mul_f32 v135, v135, v223
    v_cvt_pk_bf16_f32 v226, v132, v133
    v_cvt_pk_bf16_f32 v227, v134, v135
    buffer_store_dwordx4 v[224:227], v2, s[44:47], s73 offen offset:0 sc1
    v_mul_f32 v216, v233, v144
    v_mul_f32 v217, v233, v145
    v_mul_f32 v218, v233, v146
    v_mul_f32 v219, v233, v147
    v_exp_f32 v216, v216
    v_mul_f32 v144, v144, v152
    v_exp_f32 v217, v217
    v_mul_f32 v145, v145, v153
    v_exp_f32 v218, v218
    v_mul_f32 v146, v146, v154
    v_exp_f32 v219, v219
    v_mul_f32 v147, v147, v155
    v_fma_f32 v216, v216, v232, v232
    v_fma_f32 v217, v217, v232, v232
    v_fma_f32 v218, v218, v232, v232
    v_fma_f32 v219, v219, v232, v232
    v_rcp_f32 v216, v216
    v_rcp_f32 v217, v217
    v_rcp_f32 v218, v218
    v_rcp_f32 v219, v219
    v_mul_f32 v144, v144, v216
    v_mul_f32 v145, v145, v217
    v_mul_f32 v146, v146, v218
    v_mul_f32 v147, v147, v219
    v_cvt_pk_bf16_f32 v228, v144, v145
    v_cvt_pk_bf16_f32 v229, v146, v147
    v_mul_f32 v220, v233, v148
    v_mul_f32 v221, v233, v149
    v_mul_f32 v222, v233, v150
    v_mul_f32 v223, v233, v151
    v_exp_f32 v220, v220
    v_mul_f32 v148, v148, v156
    v_exp_f32 v221, v221
    v_mul_f32 v149, v149, v157
    v_exp_f32 v222, v222
    v_mul_f32 v150, v150, v158
    v_exp_f32 v223, v223
    v_mul_f32 v151, v151, v159
    v_fma_f32 v220, v220, v232, v232
    v_fma_f32 v221, v221, v232, v232
    v_fma_f32 v222, v222, v232, v232
    v_fma_f32 v223, v223, v232, v232
    v_rcp_f32 v220, v220
    v_rcp_f32 v221, v221
    v_rcp_f32 v222, v222
    v_rcp_f32 v223, v223
    v_mul_f32 v148, v148, v220
    v_mul_f32 v149, v149, v221
    v_mul_f32 v150, v150, v222
    v_mul_f32 v151, v151, v223
    v_cvt_pk_bf16_f32 v230, v148, v149
    v_cvt_pk_bf16_f32 v231, v150, v151
    buffer_store_dwordx4 v[228:231], v2, s[44:47], s73 offen offset:1024 sc1
    s_branch L_gemm
L_att:
    s_setprio 3
    s_and_b32 s68, s55, 1
    s_lshl1_add_u32 s62, s54, s68
    v_min_u32 v255, 2, v1
    v_lshlrev_b32 v255, 9, v255
    s_lshr_b32 s68, s62, 2
    v_lshl_add_u32 v255, s68, 7, v255
    s_mov_b32 s70, 18350080
    buffer_load_dword v254, v255, s[44:47], s70 offen sc1
    s_lshr_b32 s63, s55, 1
    s_lshl_b32 s64, s62, 17
    s_add_u32 s64, s64, 2097152
    s_and_b32 s68, s63, 0
    s_lshl_b32 s68, s68, 0
    s_lshl3_add_u32 s68, s48, s68
    s_lshl1_add_u32 s68, s68, 1
    s_lshl_b32 s58, s68, 11
    s_add_u32 s36, s22, s64
    s_addc_u32 s37, s23, 0
    s_mov_b32 s38, 0x20000
    s_mov_b32 s39, 0x20000
    s_add_u32 s40, s36, 2097152
    s_addc_u32 s41, s37, 0
    s_mov_b32 s42, 0x20000
    s_mov_b32 s43, 0x20000
    s_waitcnt lgkmcnt(0)
    v_mul_f32 v216, v233, v160
    v_mul_f32 v217, v233, v161
    v_mul_f32 v218, v233, v162
    v_mul_f32 v219, v233, v163
    v_exp_f32 v216, v216
    v_mul_f32 v160, v160, v176
    v_exp_f32 v217, v217
    v_mul_f32 v161, v161, v177
    v_exp_f32 v218, v218
    v_mul_f32 v162, v162, v178
    v_exp_f32 v219, v219
    v_mul_f32 v163, v163, v179
    v_fma_f32 v216, v216, v232, v232
    v_fma_f32 v217, v217, v232, v232
    v_fma_f32 v218, v218, v232, v232
    v_fma_f32 v219, v219, v232, v232
    v_rcp_f32 v216, v216
    v_rcp_f32 v217, v217
    v_rcp_f32 v218, v218
    v_rcp_f32 v219, v219
    v_mul_f32 v160, v160, v216
    v_mul_f32 v161, v161, v217
    v_mul_f32 v162, v162, v218
    v_mul_f32 v163, v163, v219
    v_cvt_pk_bf16_f32 v176, v160, v161
    v_cvt_pk_bf16_f32 v177, v162, v163
    s_waitcnt vmcnt(0)
    v_cmp_gt_u32 s[74:75], 16, v254
    s_nop 0
    s_cmp_eq_u64 s[74:75], 0
    s_cbranch_scc1 L_e2ok
    v_mul_f32 v220, v233, v164
    v_mul_f32 v221, v233, v165
    v_mul_f32 v222, v233, v166
    v_mul_f32 v223, v233, v167
    v_exp_f32 v220, v220
    v_mul_f32 v164, v164, v180
    v_exp_f32 v221, v221
    v_mul_f32 v165, v165, v181
    v_exp_f32 v222, v222
    v_mul_f32 v166, v166, v182
    v_exp_f32 v223, v223
    v_mul_f32 v167, v167, v183
    v_fma_f32 v220, v220, v232, v232
    v_fma_f32 v221, v221, v232, v232
    v_fma_f32 v222, v222, v232, v232
    v_fma_f32 v223, v223, v232, v232
    v_rcp_f32 v220, v220
    v_rcp_f32 v221, v221
    v_rcp_f32 v222, v222
    v_rcp_f32 v223, v223
    v_mul_f32 v164, v164, v220
    v_mul_f32 v165, v165, v221
    v_mul_f32 v166, v166, v222
    v_mul_f32 v167, v167, v223
    v_cvt_pk_bf16_f32 v178, v164, v165
    v_cvt_pk_bf16_f32 v179, v166, v167
    buffer_store_dwordx4 v[176:179], v2, s[44:47], s65 offen offset:0 sc1
    v_mul_f32 v216, v233, v168
    v_mul_f32 v217, v233, v169
    v_mul_f32 v218, v233, v170
    v_mul_f32 v219, v233, v171
    v_exp_f32 v216, v216
    v_mul_f32 v168, v168, v184
    v_exp_f32 v217, v217
    v_mul_f32 v169, v169, v185
    v_exp_f32 v218, v218
    v_mul_f32 v170, v170, v186
    v_exp_f32 v219, v219
    v_mul_f32 v171, v171, v187
    v_fma_f32 v216, v216, v232, v232
    v_fma_f32 v217, v217, v232, v232
    v_fma_f32 v218, v218, v232, v232
    v_fma_f32 v219, v219, v232, v232
    v_rcp_f32 v216, v216
    v_rcp_f32 v217, v217
    v_rcp_f32 v218, v218
    v_rcp_f32 v219, v219
    v_mul_f32 v168, v168, v216
    v_mul_f32 v169, v169, v217
    v_mul_f32 v170, v170, v218
    v_mul_f32 v171, v171, v219
    v_cvt_pk_bf16_f32 v184, v168, v169
    v_cvt_pk_bf16_f32 v185, v170, v171
    v_mul_f32 v220, v233, v172
    v_mul_f32 v221, v233, v173
    v_mul_f32 v222, v233, v174
    v_mul_f32 v223, v233, v175
    v_exp_f32 v220, v220
    v_mul_f32 v172, v172, v188
    v_exp_f32 v221, v221
    v_mul_f32 v173, v173, v189
    v_exp_f32 v222, v222
    v_mul_f32 v174, v174, v190
    v_exp_f32 v223, v223
    v_mul_f32 v175, v175, v191
    v_fma_f32 v220, v220, v232, v232
    v_fma_f32 v221, v221, v232, v232
    v_fma_f32 v222, v222, v232, v232
    v_fma_f32 v223, v223, v232, v232
    v_rcp_f32 v220, v220
    v_rcp_f32 v221, v221
    v_rcp_f32 v222, v222
    v_rcp_f32 v223, v223
    v_mul_f32 v172, v172, v220
    v_mul_f32 v173, v173, v221
    v_mul_f32 v174, v174, v222
    v_mul_f32 v175, v175, v223
    v_cvt_pk_bf16_f32 v186, v172, v173
    v_cvt_pk_bf16_f32 v187, v174, v175
    buffer_store_dwordx4 v[184:187], v2, s[44:47], s65 offen offset:1024 sc1
    s_barrier
    s_mov_b32 s69, 0x40000
    s_mov_b32 s70, 18350080
L_po88:
    buffer_load_dword v254, v255, s[44:47], s70 offen sc1
    s_waitcnt vmcnt(0)
    v_cmp_gt_u32 s[74:75], 16, v254
    s_nop 0
    s_cmp_eq_u64 s[74:75], 0
    s_cbranch_scc1 L_pd89
    s_sleep 1
    s_sub_u32 s69, s69, 1
    s_cbranch_scc0 L_po88
L_pd89:
    s_lshl_b32 s68, s62, 6
    s_lshl2_add_u32 s68, s63, s68
    s_add_u32 s68, s68, s48
    s_lshl_b32 s68, s68, 11
    buffer_load_dwordx4 v[24:27], v2, s[44:47], s68 offen sc1
    buffer_load_dwordx4 v[28:31], v2, s[44:47], s68 offen offset:1024 sc1
    buffer_load_dwordx4 v[56:59], v2, s[36:39], s58 offen offset:0 sc1
    buffer_load_dwordx4 v[60:63], v2, s[36:39], s58 offen offset:1024 sc1
    buffer_load_dwordx4 v[64:67], v2, s[40:43], s58 offen offset:0 sc1
    buffer_load_dwordx4 v[68:71], v2, s[40:43], s58 offen offset:1024 sc1
    s_add_u32 s58, s58, 2048
    s_and_b32 s58, s58, 0x1ffff
    s_waitcnt vmcnt(0)
    s_branch L_e2j
L_e2ok:
    s_lshl_b32 s68, s62, 6
    s_lshl2_add_u32 s68, s63, s68
    s_add_u32 s68, s68, s48
    s_lshl_b32 s68, s68, 11
    buffer_load_dwordx4 v[24:27], v2, s[44:47], s68 offen sc1
    buffer_load_dwordx4 v[28:31], v2, s[44:47], s68 offen offset:1024 sc1
    buffer_load_dwordx4 v[56:59], v2, s[36:39], s58 offen offset:0 sc1
    buffer_load_dwordx4 v[60:63], v2, s[36:39], s58 offen offset:1024 sc1
    buffer_load_dwordx4 v[64:67], v2, s[40:43], s58 offen offset:0 sc1
    buffer_load_dwordx4 v[68:71], v2, s[40:43], s58 offen offset:1024 sc1
    s_add_u32 s58, s58, 2048
    s_and_b32 s58, s58, 0x1ffff
    v_mul_f32 v220, v233, v164
    v_mul_f32 v221, v233, v165
    v_mul_f32 v222, v233, v166
    v_mul_f32 v223, v233, v167
    v_exp_f32 v220, v220
    v_mul_f32 v164, v164, v180
    v_exp_f32 v221, v221
    v_mul_f32 v165, v165, v181
    v_exp_f32 v222, v222
    v_mul_f32 v166, v166, v182
    v_exp_f32 v223, v223
    v_mul_f32 v167, v167, v183
    v_fma_f32 v220, v220, v232, v232
    v_fma_f32 v221, v221, v232, v232
    v_fma_f32 v222, v222, v232, v232
    v_fma_f32 v223, v223, v232, v232
    v_rcp_f32 v220, v220
    v_rcp_f32 v221, v221
    v_rcp_f32 v222, v222
    v_rcp_f32 v223, v223
    v_mul_f32 v164, v164, v220
    v_mul_f32 v165, v165, v221
    v_mul_f32 v166, v166, v222
    v_mul_f32 v167, v167, v223
    v_cvt_pk_bf16_f32 v178, v164, v165
    v_cvt_pk_bf16_f32 v179, v166, v167
    buffer_store_dwordx4 v[176:179], v2, s[44:47], s65 offen offset:0 sc1
    v_mul_f32 v216, v233, v168
    v_mul_f32 v217, v233, v169
    v_mul_f32 v218, v233, v170
    v_mul_f32 v219, v233, v171
    v_exp_f32 v216, v216
    v_mul_f32 v168, v168, v184
    v_exp_f32 v217, v217
    v_mul_f32 v169, v169, v185
    v_exp_f32 v218, v218
    v_mul_f32 v170, v170, v186
    v_exp_f32 v219, v219
    v_mul_f32 v171, v171, v187
    v_fma_f32 v216, v216, v232, v232
    v_fma_f32 v217, v217, v232, v232
    v_fma_f32 v218, v218, v232, v232
    v_fma_f32 v219, v219, v232, v232
    v_rcp_f32 v216, v216
    v_rcp_f32 v217, v217
    v_rcp_f32 v218, v218
    v_rcp_f32 v219, v219
    v_mul_f32 v168, v168, v216
    v_mul_f32 v169, v169, v217
    v_mul_f32 v170, v170, v218
    v_mul_f32 v171, v171, v219
    v_cvt_pk_bf16_f32 v184, v168, v169
    v_cvt_pk_bf16_f32 v185, v170, v171
    v_mul_f32 v220, v233, v172
    v_mul_f32 v221, v233, v173
    v_mul_f32 v222, v233, v174
    v_mul_f32 v223, v233, v175
    v_exp_f32 v220, v220
    v_mul_f32 v172, v172, v188
    v_exp_f32 v221, v221
    v_mul_f32 v173, v173, v189
    v_exp_f32 v222, v222
    v_mul_f32 v174, v174, v190
    v_exp_f32 v223, v223
    v_mul_f32 v175, v175, v191
    v_fma_f32 v220, v220, v232, v232
    v_fma_f32 v221, v221, v232, v232
    v_fma_f32 v222, v222, v232, v232
    v_fma_f32 v223, v223, v232, v232
    v_rcp_f32 v220, v220
    v_rcp_f32 v221, v221
    v_rcp_f32 v222, v222
    v_rcp_f32 v223, v223
    v_mul_f32 v172, v172, v220
    v_mul_f32 v173, v173, v221
    v_mul_f32 v174, v174, v222
    v_mul_f32 v175, v175, v223
    v_cvt_pk_bf16_f32 v186, v172, v173
    v_cvt_pk_bf16_f32 v187, v174, v175
    buffer_store_dwordx4 v[184:187], v2, s[44:47], s65 offen offset:1024 sc1
    s_barrier
L_e2j:
    buffer_load_dwordx4 v[72:75], v2, s[36:39], s58 offen offset:0 sc1
    buffer_load_dwordx4 v[76:79], v2, s[36:39], s58 offen offset:1024 sc1
    buffer_load_dwordx4 v[80:83], v2, s[40:43], s58 offen offset:0 sc1
    buffer_load_dwordx4 v[84:87], v2, s[40:43], s58 offen offset:1024 sc1
    s_add_u32 s58, s58, 2048
    s_and_b32 s58, s58, 0x1ffff
    buffer_load_dwordx4 v[88:91], v2, s[36:39], s58 offen offset:0 sc1
    buffer_load_dwordx4 v[92:95], v2, s[36:39], s58 offen offset:1024 sc1
    buffer_load_dwordx4 v[96:99], v2, s[40:43], s58 offen offset:0 sc1
    buffer_load_dwordx4 v[100:103], v2, s[40:43], s58 offen offset:1024 sc1
    s_add_u32 s58, s58, 2048
    s_and_b32 s58, s58, 0x1ffff
    s_mov_b32 s59, 0
    s_lshl2_add_u32 s61, s63, s48
    s_lshl4_add_u32 s61, s61, s62
    s_lshl_b32 s61, s61, 11
    s_add_u32 s61, s61, 13631488
    s_add_u32 s68, s48, 0
    s_and_b32 s68, s68, 3
    s_lshl_b32 s68, s68, 11
    s_add_u32 s68, s68, 147456
    v_add_u32 v242, s68, v2
    s_add_u32 s68, s48, 1
    s_and_b32 s68, s68, 3
    s_lshl_b32 s68, s68, 11
    s_add_u32 s68, s68, 147456
    v_add_u32 v243, s68, v2
    s_add_u32 s68, s48, 2
    s_and_b32 s68, s68, 3
    s_lshl_b32 s68, s68, 11
    s_add_u32 s68, s68, 147456
    v_add_u32 v244, s68, v2
    s_add_u32 s68, s48, 3
    s_and_b32 s68, s68, 3
    s_lshl_b32 s68, s68, 11
    s_add_u32 s68, s68, 147456
    v_add_u32 v245, s68, v2
    s_waitcnt vmcnt(10)
    v_mfma_f32_32x32x16_bf16 v[192:207], v[56:59], v[24:27], 0
    v_mfma_f32_32x32x16_bf16 v[192:207], v[60:63], v[28:31], v[192:207]
    v_mov_b32 v128, 0
    v_mov_b32 v129, 0
    v_mov_b32 v130, 0
    v_mov_b32 v131, 0
    v_mov_b32 v132, 0
    v_mov_b32 v133, 0
    v_mov_b32 v134, 0
    v_mov_b32 v135, 0
    v_mov_b32 v136, 0
    v_mov_b32 v137, 0
    v_mov_b32 v138, 0
    v_mov_b32 v139, 0
    v_mov_b32 v140, 0
    v_mov_b32 v141, 0
    v_max3_f32 v252, v192, v193, v194
    v_max3_f32 v253, v196, v197, v198
    v_max3_f32 v254, v200, v201, v202
    v_max3_f32 v255, v204, v205, v206
    v_max3_f32 v252, v252, v253, v195
    v_max3_f32 v254, v254, v255, v203
    v_max3_f32 v248, v199, v207, v252
    v_max_f32 v248, v248, v254
    v_mov_b32 v252, v248
    s_nop 1
    v_permlane32_swap_b32 v248, v252
    v_max_f32 v248, v248, v252
    v_sub_f32 v248, 0xc2800000, v248
    v_cvt_pk_bf16_f32 v252, v248, v248
    v_and_b32 v252, 0xffff0000, v252
    v_sub_f32 v252, v248, v252
    v_cvt_pk_bf16_f32 v248, v248, v252
    v_cndmask_b32 v30, v248, v30, vcc
    v_and_b32 v248, 0xffff0000, v248
    v_sub_f32 v252, v252, v248
    v_cvt_pk_bf16_f32 v252, v252, 0
    v_cndmask_b32 v31, v252, v31, vcc
    ds_write_b128 v242, v[24:27]
    ds_write_b128 v242, v[28:31] offset:1024
    v_mov_b32 v142, 0
    v_mov_b32 v143, 0
    v_mov_b32 v144, 0
    v_mov_b32 v145, 0
    v_mov_b32 v146, 0
    v_mov_b32 v147, 0
    v_mov_b32 v148, 0
    v_mov_b32 v149, 0
    v_mov_b32 v150, 0
    v_mov_b32 v151, 0
    v_mov_b32 v152, 0
    v_mov_b32 v153, 0
    v_mov_b32 v154, 0
    v_mov_b32 v155, 0
    v_mov_b32 v156, 0
    v_mov_b32 v157, 0
    s_waitcnt lgkmcnt(0)
    v_mov_b32 v240, 163588
    v_mov_b32 v241, 1
    s_mov_b64 exec, 1
    ds_add_u32 v240, v241
    s_mov_b64 exec, -1
    s_nop 3
    v_mfma_f32_32x32x16_bf16 v[192:207], v[56:59], v[24:27], 0
    v_mfma_f32_32x32x16_bf16 v[192:207], v[60:63], v[28:31], v[192:207]
    v_mov_b32 v158, 0
    v_mov_b32 v159, 0
    v_mov_b32 v160, 0
    v_mov_b32 v161, 0
    v_mov_b32 v162, 0
    v_mov_b32 v163, 0
    v_mov_b32 v164, 0
    v_mov_b32 v165, 0
    v_mov_b32 v166, 0
    v_mov_b32 v167, 0
    v_mov_b32 v168, 0
    v_mov_b32 v169, 0
    v_mov_b32 v170, 0
    v_mov_b32 v171, 0
    v_mov_b32 v172, 0
    v_mov_b32 v173, 0
    v_mov_b32 v174, 0
    v_mov_b32 v175, 0
    v_mov_b32 v176, 0
    v_mov_b32 v177, 0
    v_mov_b32 v178, 0
    v_mov_b32 v179, 0
    v_mov_b32 v180, 0
    v_mov_b32 v181, 0
    s_mov_b32 s69, 0x400000
L_ls90:
    ds_read_b32 v241, v240
    s_waitcnt lgkmcnt(0)
    v_readfirstlane_b32 s68, v241
    s_sub_u32 s69, s69, 1
    s_cselect_b32 s68, 4, s68
    s_cmp_lt_u32 s68, 4
    s_cbranch_scc1 L_ls90
    ds_read_b128 v[32:35], v243
    ds_read_b128 v[36:39], v243 offset:1024
    ds_read_b128 v[40:43], v244
    ds_read_b128 v[44:47], v244 offset:1024
    ds_read_b128 v[48:51], v245
    ds_read_b128 v[52:55], v245 offset:1024
    v_mov_b32 v182, 0
    v_mov_b32 v183, 0
    v_mov_b32 v184, 0
    v_mov_b32 v185, 0
    v_mov_b32 v186, 0
    v_mov_b32 v187, 0
    v_mov_b32 v188, 0
    v_mov_b32 v189, 0
    v_mov_b32 v190, 0
    v_mov_b32 v191, 0
    v_mov_b32 v232, 0
    v_mov_b32 v233, 0
    v_mov_b32 v234, 0
    v_mov_b32 v235, 0
    v_mov_b32 v236, 0
    v_mov_b32 v237, 0
    v_mov_b32 v238, 0
    v_mov_b32 v239, 0
    v_mov_b32 v112, 0
    v_mov_b32 v113, 0
    v_mov_b32 v114, 0
    v_mov_b32 v115, 0
    v_mov_b32 v116, 0
    v_mov_b32 v117, 0
    v_mov_b32 v118, 0
    v_mov_b32 v119, 0
    s_waitcnt vmcnt(8)
    v_mov_b32 v240, 163584
    v_mov_b32 v241, 1
    s_mov_b64 exec, 1
    ds_add_rtn_u32 v241, v240, v241
    s_mov_b64 exec, -1
    s_waitcnt lgkmcnt(0)
    v_readfirstlane_b32 s68, v241
    s_nop 0
    s_cmp_lg_u32 s68, 7
    s_cbranch_scc1 L_ns91
    s_add_u32 s68, s51, 12
    s_lshl_b32 s68, s68, 7
    s_add_u32 s68, s68, 18350080
    v_mov_b32 v240, 0
    v_mov_b32 v241, 1
    s_mov_b64 exec, 1
    buffer_atomic_add v241, v240, s[44:47], s68 offen sc1
    s_mov_b64 exec, -1
L_ns91:
    v_mov_b32 v240, 163592
    v_mov_b32 v241, 1
    s_mov_b64 exec, 1
    ds_add_u32 v240, v241
    s_mov_b64 exec, -1
    s_setprio 1
    s_add_u32 s68, s48, 0
    s_and_b32 s68, s68, 3
    s_mul_i32 s68, s68, 12288
    s_add_u32 s68, s68, 49152
    v_add_u32 v240, s68, v2
    s_add_u32 s68, s48, 1
    s_and_b32 s68, s68, 3
    s_mul_i32 s68, s68, 12288
    s_add_u32 s68, s68, 49152
    v_add_u32 v241, s68, v2
    s_add_u32 s68, s48, 2
    s_and_b32 s68, s68, 3
    s_mul_i32 s68, s68, 12288
    s_add_u32 s68, s68, 49152
    v_add_u32 v242, s68, v2
    s_add_u32 s68, s48, 3
    s_and_b32 s68, s68, 3
    s_mul_i32 s68, s68, 12288
    s_add_u32 s68, s68, 49152
    v_add_u32 v243, s68, v2
    s_mov_b32 s60, 2
.p2align 6
L_loop:
    v_mfma_f32_32x32x16_bf16 v[208:223], v[56:59], v[32:35], 0
    v_exp_f32 v192, v192
    v_exp_f32 v193, v193
    v_exp_f32 v194, v194
    v_mfma_f32_32x32x16_bf16 v[208:223], v[60:63], v[36:39], v[208:223]
    v_exp_f32 v195, v195
    v_exp_f32 v196, v196
    v_exp_f32 v197, v197
    v_mfma_f32_32x32x16_bf16 v[176:191], v[112:115], v[232:235], v[176:191]
    v_exp_f32 v198, v198
    v_exp_f32 v199, v199
    v_exp_f32 v200, v200
    v_mfma_f32_32x32x16_bf16 v[176:191], v[116:119], v[236:239], v[176:191]
    v_exp_f32 v201, v201
    v_exp_f32 v202, v202
    v_exp_f32 v203, v203
    buffer_load_dwordx4 v[104:107], v2, s[36:39], s58 offen offset:0 sc1
    buffer_load_dwordx4 v[108:111], v2, s[36:39], s58 offen offset:1024 sc1
    buffer_load_dwordx4 v[112:115], v2, s[40:43], s58 offen offset:0 sc1
    buffer_load_dwordx4 v[116:119], v2, s[40:43], s58 offen offset:1024 sc1
    v_exp_f32 v204, v204
    v_exp_f32 v205, v205
    v_exp_f32 v206, v206
    v_exp_f32 v207, v207
    v_cvt_pk_bf16_f32 v224, v192, v193
    v_cvt_pk_bf16_f32 v225, v194, v195
    v_cvt_pk_bf16_f32 v226, v196, v197
    v_cvt_pk_bf16_f32 v227, v198, v199
    v_cvt_pk_bf16_f32 v228, v200, v201
    v_cvt_pk_bf16_f32 v229, v202, v203
    v_cvt_pk_bf16_f32 v230, v204, v205
    v_cvt_pk_bf16_f32 v231, v206, v207
    v_mfma_f32_32x32x16_bf16 v[192:207], v[56:59], v[40:43], 0
    v_exp_f32 v208, v208
    v_exp_f32 v209, v209
    v_exp_f32 v210, v210
    v_mfma_f32_32x32x16_bf16 v[192:207], v[60:63], v[44:47], v[192:207]
    v_exp_f32 v211, v211
    v_exp_f32 v212, v212
    v_exp_f32 v213, v213
    v_mfma_f32_32x32x16_bf16 v[128:143], v[64:67], v[224:227], v[128:143]
    v_exp_f32 v214, v214
    v_exp_f32 v215, v215
    v_exp_f32 v216, v216
    v_mfma_f32_32x32x16_bf16 v[128:143], v[68:71], v[228:231], v[128:143]
    v_exp_f32 v217, v217
    v_exp_f32 v218, v218
    v_exp_f32 v219, v219
    v_exp_f32 v220, v220
    v_exp_f32 v221, v221
    v_exp_f32 v222, v222
    v_exp_f32 v223, v223
    v_cvt_pk_bf16_f32 v232, v208, v209
    v_cvt_pk_bf16_f32 v233, v210, v211
    v_cvt_pk_bf16_f32 v234, v212, v213
    v_cvt_pk_bf16_f32 v235, v214, v215
    v_cvt_pk_bf16_f32 v236, v216, v217
    v_cvt_pk_bf16_f32 v237, v218, v219
    v_cvt_pk_bf16_f32 v238, v220, v221
    v_cvt_pk_bf16_f32 v239, v222, v223
    v_mfma_f32_32x32x16_bf16 v[208:223], v[56:59], v[48:51], 0
    v_exp_f32 v192, v192
    v_exp_f32 v193, v193
    v_exp_f32 v194, v194
    v_mfma_f32_32x32x16_bf16 v[208:223], v[60:63], v[52:55], v[208:223]
    v_exp_f32 v195, v195
    v_exp_f32 v196, v196
    v_exp_f32 v197, v197
    v_mfma_f32_32x32x16_bf16 v[144:159], v[64:67], v[232:235], v[144:159]
    v_exp_f32 v198, v198
    v_exp_f32 v199, v199
    v_exp_f32 v200, v200
    v_mfma_f32_32x32x16_bf16 v[144:159], v[68:71], v[236:239], v[144:159]
    v_exp_f32 v201, v201
    v_exp_f32 v202, v202
    v_exp_f32 v203, v203
    v_exp_f32 v204, v204
    v_exp_f32 v205, v205
    v_exp_f32 v206, v206
    v_exp_f32 v207, v207
    v_cvt_pk_bf16_f32 v224, v192, v193
    v_cvt_pk_bf16_f32 v225, v194, v195
    v_cvt_pk_bf16_f32 v226, v196, v197
    v_cvt_pk_bf16_f32 v227, v198, v199
    v_cvt_pk_bf16_f32 v228, v200, v201
    v_cvt_pk_bf16_f32 v229, v202, v203
    v_cvt_pk_bf16_f32 v230, v204, v205
    v_cvt_pk_bf16_f32 v231, v206, v207
    s_waitcnt vmcnt(8)
    v_mfma_f32_32x32x16_bf16 v[192:207], v[72:75], v[24:27], 0
    v_exp_f32 v208, v208
    v_exp_f32 v209, v209
    v_exp_f32 v210, v210
    v_mfma_f32_32x32x16_bf16 v[192:207], v[76:79], v[28:31], v[192:207]
    v_exp_f32 v211, v211
    v_exp_f32 v212, v212
    v_exp_f32 v213, v213
    v_mfma_f32_32x32x16_bf16 v[160:175], v[64:67], v[224:227], v[160:175]
    v_exp_f32 v214, v214
    v_exp_f32 v215, v215
    v_exp_f32 v216, v216
    v_mfma_f32_32x32x16_bf16 v[160:175], v[68:71], v[228:231], v[160:175]
    v_exp_f32 v217, v217
    v_exp_f32 v218, v218
    v_exp_f32 v219, v219
    v_exp_f32 v220, v220
    v_exp_f32 v221, v221
    v_exp_f32 v222, v222
    v_exp_f32 v223, v223
    v_cvt_pk_bf16_f32 v232, v208, v209
    v_cvt_pk_bf16_f32 v233, v210, v211
    v_cvt_pk_bf16_f32 v234, v212, v213
    v_cvt_pk_bf16_f32 v235, v214, v215
    v_cvt_pk_bf16_f32 v236, v216, v217
    v_cvt_pk_bf16_f32 v237, v218, v219
    v_cvt_pk_bf16_f32 v238, v220, v221
    v_cvt_pk_bf16_f32 v239, v222, v223
    v_mfma_f32_32x32x16_bf16 v[208:223], v[72:75], v[32:35], 0
    v_exp_f32 v192, v192
    v_exp_f32 v193, v193
    v_exp_f32 v194, v194
    v_mfma_f32_32x32x16_bf16 v[208:223], v[76:79], v[36:39], v[208:223]
    v_exp_f32 v195, v195
    v_exp_f32 v196, v196
    v_exp_f32 v197, v197
    v_mfma_f32_32x32x16_bf16 v[176:191], v[64:67], v[232:235], v[176:191]
    v_exp_f32 v198, v198
    v_exp_f32 v199, v199
    v_exp_f32 v200, v200
    v_mfma_f32_32x32x16_bf16 v[176:191], v[68:71], v[236:239], v[176:191]
    v_exp_f32 v201, v201
    v_exp_f32 v202, v202
    v_exp_f32 v203, v203
    buffer_load_dwordx4 v[56:59], v2, s[36:39], s58 offen offset:2048 sc1
    buffer_load_dwordx4 v[60:63], v2, s[36:39], s58 offen offset:3072 sc1
    buffer_load_dwordx4 v[64:67], v2, s[40:43], s58 offen offset:2048 sc1
    buffer_load_dwordx4 v[68:71], v2, s[40:43], s58 offen offset:3072 sc1
    s_add_u32 s58, s58, 4096
    s_and_b32 s58, s58, 0x1ffff
    v_exp_f32 v204, v204
    v_exp_f32 v205, v205
    v_exp_f32 v206, v206
    v_exp_f32 v207, v207
    v_cvt_pk_bf16_f32 v224, v192, v193
    v_cvt_pk_bf16_f32 v225, v194, v195
    v_cvt_pk_bf16_f32 v226, v196, v197
    v_cvt_pk_bf16_f32 v227, v198, v199
    v_cvt_pk_bf16_f32 v228, v200, v201
    v_cvt_pk_bf16_f32 v229, v202, v203
    v_cvt_pk_bf16_f32 v230, v204, v205
    v_cvt_pk_bf16_f32 v231, v206, v207
    v_mfma_f32_32x32x16_bf16 v[192:207], v[72:75], v[40:43], 0
    v_exp_f32 v208, v208
    v_exp_f32 v209, v209
    v_exp_f32 v210, v210
    v_mfma_f32_32x32x16_bf16 v[192:207], v[76:79], v[44:47], v[192:207]
    v_exp_f32 v211, v211
    v_exp_f32 v212, v212
    v_exp_f32 v213, v213
    v_mfma_f32_32x32x16_bf16 v[128:143], v[80:83], v[224:227], v[128:143]
    v_exp_f32 v214, v214
    v_exp_f32 v215, v215
    v_exp_f32 v216, v216
    v_mfma_f32_32x32x16_bf16 v[128:143], v[84:87], v[228:231], v[128:143]
    v_exp_f32 v217, v217
    v_exp_f32 v218, v218
    v_exp_f32 v219, v219
    v_exp_f32 v220, v220
    v_exp_f32 v221, v221
    v_exp_f32 v222, v222
    v_exp_f32 v223, v223
    v_cvt_pk_bf16_f32 v232, v208, v209
    v_cvt_pk_bf16_f32 v233, v210, v211
    v_cvt_pk_bf16_f32 v234, v212, v213
    v_cvt_pk_bf16_f32 v235, v214, v215
    v_cvt_pk_bf16_f32 v236, v216, v217
    v_cvt_pk_bf16_f32 v237, v218, v219
    v_cvt_pk_bf16_f32 v238, v220, v221
    v_cvt_pk_bf16_f32 v239, v222, v223
    v_mfma_f32_32x32x16_bf16 v[208:223], v[72:75], v[48:51], 0
    v_exp_f32 v192, v192
    v_exp_f32 v193, v193
    v_exp_f32 v194, v194
    v_mfma_f32_32x32x16_bf16 v[208:223], v[76:79], v[52:55], v[208:223]
    v_exp_f32 v195, v195
    v_exp_f32 v196, v196
    v_exp_f32 v197, v197
    v_mfma_f32_32x32x16_bf16 v[144:159], v[80:83], v[232:235], v[144:159]
    v_exp_f32 v198, v198
    v_exp_f32 v199, v199
    v_exp_f32 v200, v200
    v_mfma_f32_32x32x16_bf16 v[144:159], v[84:87], v[236:239], v[144:159]
    v_exp_f32 v201, v201
    v_exp_f32 v202, v202
    v_exp_f32 v203, v203
    v_exp_f32 v204, v204
    v_exp_f32 v205, v205
    v_exp_f32 v206, v206
    v_exp_f32 v207, v207
    v_cvt_pk_bf16_f32 v224, v192, v193
    v_cvt_pk_bf16_f32 v225, v194, v195
    v_cvt_pk_bf16_f32 v226, v196, v197
    v_cvt_pk_bf16_f32 v227, v198, v199
    v_cvt_pk_bf16_f32 v228, v200, v201
    v_cvt_pk_bf16_f32 v229, v202, v203
    v_cvt_pk_bf16_f32 v230, v204, v205
    v_cvt_pk_bf16_f32 v231, v206, v207
    s_waitcnt vmcnt(8)
    v_mfma_f32_32x32x16_bf16 v[192:207], v[88:91], v[24:27], 0
    v_exp_f32 v208, v208
    v_exp_f32 v209, v209
    v_exp_f32 v210, v210
    v_mfma_f32_32x32x16_bf16 v[192:207], v[92:95], v[28:31], v[192:207]
    v_exp_f32 v211, v211
    v_exp_f32 v212, v212
    v_exp_f32 v213, v213
    v_mfma_f32_32x32x16_bf16 v[160:175], v[80:83], v[224:227], v[160:175]
    v_exp_f32 v214, v214
    v_exp_f32 v215, v215
    v_exp_f32 v216, v216
    v_mfma_f32_32x32x16_bf16 v[160:175], v[84:87], v[228:231], v[160:175]
    v_exp_f32 v217, v217
    v_exp_f32 v218, v218
    v_exp_f32 v219, v219
    v_exp_f32 v220, v220
    v_exp_f32 v221, v221
    v_exp_f32 v222, v222
    v_exp_f32 v223, v223
    v_cvt_pk_bf16_f32 v232, v208, v209
    v_cvt_pk_bf16_f32 v233, v210, v211
    v_cvt_pk_bf16_f32 v234, v212, v213
    v_cvt_pk_bf16_f32 v235, v214, v215
    v_cvt_pk_bf16_f32 v236, v216, v217
    v_cvt_pk_bf16_f32 v237, v218, v219
    v_cvt_pk_bf16_f32 v238, v220, v221
    v_cvt_pk_bf16_f32 v239, v222, v223
    v_mfma_f32_32x32x16_bf16 v[208:223], v[88:91], v[32:35], 0
    v_exp_f32 v192, v192
    v_exp_f32 v193, v193
    v_exp_f32 v194, v194
    v_mfma_f32_32x32x16_bf16 v[208:223], v[92:95], v[36:39], v[208:223]
    v_exp_f32 v195, v195
    v_exp_f32 v196, v196
    v_exp_f32 v197, v197
    v_mfma_f32_32x32x16_bf16 v[176:191], v[80:83], v[232:235], v[176:191]
    v_exp_f32 v198, v198
    v_exp_f32 v199, v199
    v_exp_f32 v200, v200
    v_mfma_f32_32x32x16_bf16 v[176:191], v[84:87], v[236:239], v[176:191]
    v_exp_f32 v201, v201
    v_exp_f32 v202, v202
    v_exp_f32 v203, v203
    buffer_load_dwordx4 v[72:75], v2, s[36:39], s58 offen offset:0 sc1
    buffer_load_dwordx4 v[76:79], v2, s[36:39], s58 offen offset:1024 sc1
    buffer_load_dwordx4 v[80:83], v2, s[40:43], s58 offen offset:0 sc1
    buffer_load_dwordx4 v[84:87], v2, s[40:43], s58 offen offset:1024 sc1
    v_exp_f32 v204, v204
    v_exp_f32 v205, v205
    v_exp_f32 v206, v206
    v_exp_f32 v207, v207
    v_cvt_pk_bf16_f32 v224, v192, v193
    v_cvt_pk_bf16_f32 v225, v194, v195
    v_cvt_pk_bf16_f32 v226, v196, v197
    v_cvt_pk_bf16_f32 v227, v198, v199
    v_cvt_pk_bf16_f32 v228, v200, v201
    v_cvt_pk_bf16_f32 v229, v202, v203
    v_cvt_pk_bf16_f32 v230, v204, v205
    v_cvt_pk_bf16_f32 v231, v206, v207
    v_mfma_f32_32x32x16_bf16 v[192:207], v[88:91], v[40:43], 0
    v_exp_f32 v208, v208
    v_exp_f32 v209, v209
    v_exp_f32 v210, v210
    v_mfma_f32_32x32x16_bf16 v[192:207], v[92:95], v[44:47], v[192:207]
    v_exp_f32 v211, v211
    v_exp_f32 v212, v212
    v_exp_f32 v213, v213
    v_mfma_f32_32x32x16_bf16 v[128:143], v[96:99], v[224:227], v[128:143]
    v_exp_f32 v214, v214
    v_exp_f32 v215, v215
    v_exp_f32 v216, v216
    v_mfma_f32_32x32x16_bf16 v[128:143], v[100:103], v[228:231], v[128:143]
    v_exp_f32 v217, v217
    v_exp_f32 v218, v218
    v_exp_f32 v219, v219
    v_exp_f32 v220, v220
    v_exp_f32 v221, v221
    v_exp_f32 v222, v222
    v_exp_f32 v223, v223
    v_cvt_pk_bf16_f32 v232, v208, v209
    v_cvt_pk_bf16_f32 v233, v210, v211
    v_cvt_pk_bf16_f32 v234, v212, v213
    v_cvt_pk_bf16_f32 v235, v214, v215
    v_cvt_pk_bf16_f32 v236, v216, v217
    v_cvt_pk_bf16_f32 v237, v218, v219
    v_cvt_pk_bf16_f32 v238, v220, v221
    v_cvt_pk_bf16_f32 v239, v222, v223
    v_mfma_f32_32x32x16_bf16 v[208:223], v[88:91], v[48:51], 0
    v_exp_f32 v192, v192
    v_exp_f32 v193, v193
    v_exp_f32 v194, v194
    v_mfma_f32_32x32x16_bf16 v[208:223], v[92:95], v[52:55], v[208:223]
    v_exp_f32 v195, v195
    v_exp_f32 v196, v196
    v_exp_f32 v197, v197
    v_mfma_f32_32x32x16_bf16 v[144:159], v[96:99], v[232:235], v[144:159]
    v_exp_f32 v198, v198
    v_exp_f32 v199, v199
    v_exp_f32 v200, v200
    v_mfma_f32_32x32x16_bf16 v[144:159], v[100:103], v[236:239], v[144:159]
    v_exp_f32 v201, v201
    v_exp_f32 v202, v202
    v_exp_f32 v203, v203
    v_exp_f32 v204, v204
    v_exp_f32 v205, v205
    v_exp_f32 v206, v206
    v_exp_f32 v207, v207
    v_cvt_pk_bf16_f32 v224, v192, v193
    v_cvt_pk_bf16_f32 v225, v194, v195
    v_cvt_pk_bf16_f32 v226, v196, v197
    v_cvt_pk_bf16_f32 v227, v198, v199
    v_cvt_pk_bf16_f32 v228, v200, v201
    v_cvt_pk_bf16_f32 v229, v202, v203
    v_cvt_pk_bf16_f32 v230, v204, v205
    v_cvt_pk_bf16_f32 v231, v206, v207
    s_waitcnt vmcnt(8)
    v_mfma_f32_32x32x16_bf16 v[192:207], v[104:107], v[24:27], 0
    v_exp_f32 v208, v208
    v_exp_f32 v209, v209
    v_exp_f32 v210, v210
    v_mfma_f32_32x32x16_bf16 v[192:207], v[108:111], v[28:31], v[192:207]
    v_exp_f32 v211, v211
    v_exp_f32 v212, v212
    v_exp_f32 v213, v213
    v_mfma_f32_32x32x16_bf16 v[160:175], v[96:99], v[224:227], v[160:175]
    v_exp_f32 v214, v214
    v_exp_f32 v215, v215
    v_exp_f32 v216, v216
    v_mfma_f32_32x32x16_bf16 v[160:175], v[100:103], v[228:231], v[160:175]
    v_exp_f32 v217, v217
    v_exp_f32 v218, v218
    v_exp_f32 v219, v219
    v_exp_f32 v220, v220
    v_exp_f32 v221, v221
    v_exp_f32 v222, v222
    v_exp_f32 v223, v223
    v_cvt_pk_bf16_f32 v232, v208, v209
    v_cvt_pk_bf16_f32 v233, v210, v211
    v_cvt_pk_bf16_f32 v234, v212, v213
    v_cvt_pk_bf16_f32 v235, v214, v215
    v_cvt_pk_bf16_f32 v236, v216, v217
    v_cvt_pk_bf16_f32 v237, v218, v219
    v_cvt_pk_bf16_f32 v238, v220, v221
    v_cvt_pk_bf16_f32 v239, v222, v223
    v_mfma_f32_32x32x16_bf16 v[208:223], v[104:107], v[32:35], 0
    v_exp_f32 v192, v192
    v_exp_f32 v193, v193
    v_exp_f32 v194, v194
    v_mfma_f32_32x32x16_bf16 v[208:223], v[108:111], v[36:39], v[208:223]
    v_exp_f32 v195, v195
    v_exp_f32 v196, v196
    v_exp_f32 v197, v197
    v_mfma_f32_32x32x16_bf16 v[176:191], v[96:99], v[232:235], v[176:191]
    v_exp_f32 v198, v198
    v_exp_f32 v199, v199
    v_exp_f32 v200, v200
    v_mfma_f32_32x32x16_bf16 v[176:191], v[100:103], v[236:239], v[176:191]
    v_exp_f32 v201, v201
    v_exp_f32 v202, v202
    v_exp_f32 v203, v203
    buffer_load_dwordx4 v[88:91], v2, s[36:39], s58 offen offset:2048 sc1
    buffer_load_dwordx4 v[92:95], v2, s[36:39], s58 offen offset:3072 sc1
    buffer_load_dwordx4 v[96:99], v2, s[40:43], s58 offen offset:2048 sc1
    buffer_load_dwordx4 v[100:103], v2, s[40:43], s58 offen offset:3072 sc1
    s_add_u32 s58, s58, 4096
    s_and_b32 s58, s58, 0x1ffff
    v_exp_f32 v204, v204
    v_exp_f32 v205, v205
    v_exp_f32 v206, v206
    v_exp_f32 v207, v207
    v_cvt_pk_bf16_f32 v224, v192, v193
    v_cvt_pk_bf16_f32 v225, v194, v195
    v_cvt_pk_bf16_f32 v226, v196, v197
    v_cvt_pk_bf16_f32 v227, v198, v199
    v_cvt_pk_bf16_f32 v228, v200, v201
    v_cvt_pk_bf16_f32 v229, v202, v203
    v_cvt_pk_bf16_f32 v230, v204, v205
    v_cvt_pk_bf16_f32 v231, v206, v207
    v_mfma_f32_32x32x16_bf16 v[192:207], v[104:107], v[40:43], 0
    v_exp_f32 v208, v208
    v_exp_f32 v209, v209
    v_exp_f32 v210, v210
    v_mfma_f32_32x32x16_bf16 v[192:207], v[108:111], v[44:47], v[192:207]
    v_exp_f32 v211, v211
    v_exp_f32 v212, v212
    v_exp_f32 v213, v213
    v_mfma_f32_32x32x16_bf16 v[128:143], v[112:115], v[224:227], v[128:143]
    v_exp_f32 v214, v214
    v_exp_f32 v215, v215
    v_exp_f32 v216, v216
    v_mfma_f32_32x32x16_bf16 v[128:143], v[116:119], v[228:231], v[128:143]
    v_exp_f32 v217, v217
    v_exp_f32 v218, v218
    v_exp_f32 v219, v219
    v_exp_f32 v220, v220
    v_exp_f32 v221, v221
    v_exp_f32 v222, v222
    v_exp_f32 v223, v223
    v_cvt_pk_bf16_f32 v232, v208, v209
    v_cvt_pk_bf16_f32 v233, v210, v211
    v_cvt_pk_bf16_f32 v234, v212, v213
    v_cvt_pk_bf16_f32 v235, v214, v215
    v_cvt_pk_bf16_f32 v236, v216, v217
    v_cvt_pk_bf16_f32 v237, v218, v219
    v_cvt_pk_bf16_f32 v238, v220, v221
    v_cvt_pk_bf16_f32 v239, v222, v223
    v_mfma_f32_32x32x16_bf16 v[208:223], v[104:107], v[48:51], 0
    v_exp_f32 v192, v192
    v_exp_f32 v193, v193
    v_exp_f32 v194, v194
    v_mfma_f32_32x32x16_bf16 v[208:223], v[108:111], v[52:55], v[208:223]
    v_exp_f32 v195, v195
    v_exp_f32 v196, v196
    v_exp_f32 v197, v197
    v_mfma_f32_32x32x16_bf16 v[144:159], v[112:115], v[232:235], v[144:159]
    v_exp_f32 v198, v198
    v_exp_f32 v199, v199
    v_exp_f32 v200, v200
    v_mfma_f32_32x32x16_bf16 v[144:159], v[116:119], v[236:239], v[144:159]
    v_exp_f32 v201, v201
    v_exp_f32 v202, v202
    v_exp_f32 v203, v203
    v_exp_f32 v204, v204
    v_exp_f32 v205, v205
    v_exp_f32 v206, v206
    v_exp_f32 v207, v207
    v_cvt_pk_bf16_f32 v224, v192, v193
    v_cvt_pk_bf16_f32 v225, v194, v195
    v_cvt_pk_bf16_f32 v226, v196, v197
    v_cvt_pk_bf16_f32 v227, v198, v199
    v_cvt_pk_bf16_f32 v228, v200, v201
    v_cvt_pk_bf16_f32 v229, v202, v203
    v_cvt_pk_bf16_f32 v230, v204, v205
    v_cvt_pk_bf16_f32 v231, v206, v207
    s_waitcnt vmcnt(8)
    v_mfma_f32_32x32x16_bf16 v[192:207], v[56:59], v[24:27], 0
    v_exp_f32 v208, v208
    v_exp_f32 v209, v209
    v_exp_f32 v210, v210
    v_mfma_f32_32x32x16_bf16 v[192:207], v[60:63], v[28:31], v[192:207]
    v_exp_f32 v211, v211
    v_exp_f32 v212, v212
    v_exp_f32 v213, v213
    v_mfma_f32_32x32x16_bf16 v[160:175], v[112:115], v[224:227], v[160:175]
    v_exp_f32 v214, v214
    v_exp_f32 v215, v215
    v_exp_f32 v216, v216
    v_mfma_f32_32x32x16_bf16 v[160:175], v[116:119], v[228:231], v[160:175]
    v_exp_f32 v217, v217
    v_exp_f32 v218, v218
    v_exp_f32 v219, v219
    v_exp_f32 v220, v220
    v_exp_f32 v221, v221
    v_exp_f32 v222, v222
    v_exp_f32 v223, v223
    v_cvt_pk_bf16_f32 v232, v208, v209
    v_cvt_pk_bf16_f32 v233, v210, v211
    v_cvt_pk_bf16_f32 v234, v212, v213
    v_cvt_pk_bf16_f32 v235, v214, v215
    v_cvt_pk_bf16_f32 v236, v216, v217
    v_cvt_pk_bf16_f32 v237, v218, v219
    v_cvt_pk_bf16_f32 v238, v220, v221
    v_cvt_pk_bf16_f32 v239, v222, v223
    s_sub_u32 s60, s60, 1
    s_cbranch_scc0 L_loop
    v_mfma_f32_32x32x16_bf16 v[208:223], v[56:59], v[32:35], 0
    v_exp_f32 v192, v192
    v_exp_f32 v193, v193
    v_exp_f32 v194, v194
    v_mfma_f32_32x32x16_bf16 v[208:223], v[60:63], v[36:39], v[208:223]
    v_exp_f32 v195, v195
    v_exp_f32 v196, v196
    v_exp_f32 v197, v197
    v_mfma_f32_32x32x16_bf16 v[176:191], v[112:115], v[232:235], v[176:191]
    v_exp_f32 v198, v198
    v_exp_f32 v199, v199
    v_exp_f32 v200, v200
    v_mfma_f32_32x32x16_bf16 v[176:191], v[116:119], v[236:239], v[176:191]
    v_exp_f32 v201, v201
    v_exp_f32 v202, v202
    v_exp_f32 v203, v203
    buffer_load_dwordx4 v[104:107], v2, s[36:39], s58 offen offset:0 sc1
    buffer_load_dwordx4 v[108:111], v2, s[36:39], s58 offen offset:1024 sc1
    buffer_load_dwordx4 v[112:115], v2, s[40:43], s58 offen offset:0 sc1
    buffer_load_dwordx4 v[116:119], v2, s[40:43], s58 offen offset:1024 sc1
    v_exp_f32 v204, v204
    v_exp_f32 v205, v205
    v_exp_f32 v206, v206
    v_exp_f32 v207, v207
    v_cvt_pk_bf16_f32 v224, v192, v193
    v_cvt_pk_bf16_f32 v225, v194, v195
    v_cvt_pk_bf16_f32 v226, v196, v197
    v_cvt_pk_bf16_f32 v227, v198, v199
    v_cvt_pk_bf16_f32 v228, v200, v201
    v_cvt_pk_bf16_f32 v229, v202, v203
    v_cvt_pk_bf16_f32 v230, v204, v205
    v_cvt_pk_bf16_f32 v231, v206, v207
    v_mfma_f32_32x32x16_bf16 v[192:207], v[56:59], v[40:43], 0
    v_exp_f32 v208, v208
    v_exp_f32 v209, v209
    v_exp_f32 v210, v210
    v_mfma_f32_32x32x16_bf16 v[192:207], v[60:63], v[44:47], v[192:207]
    v_exp_f32 v211, v211
    v_exp_f32 v212, v212
    v_exp_f32 v213, v213
    v_mfma_f32_32x32x16_bf16 v[128:143], v[64:67], v[224:227], v[128:143]
    v_exp_f32 v214, v214
    v_exp_f32 v215, v215
    v_exp_f32 v216, v216
    v_mfma_f32_32x32x16_bf16 v[128:143], v[68:71], v[228:231], v[128:143]
    v_exp_f32 v217, v217
    v_exp_f32 v218, v218
    v_exp_f32 v219, v219
    v_exp_f32 v220, v220
    v_exp_f32 v221, v221
    v_exp_f32 v222, v222
    v_exp_f32 v223, v223
    v_cvt_pk_bf16_f32 v232, v208, v209
    v_cvt_pk_bf16_f32 v233, v210, v211
    v_cvt_pk_bf16_f32 v234, v212, v213
    v_cvt_pk_bf16_f32 v235, v214, v215
    v_cvt_pk_bf16_f32 v236, v216, v217
    v_cvt_pk_bf16_f32 v237, v218, v219
    v_cvt_pk_bf16_f32 v238, v220, v221
    v_cvt_pk_bf16_f32 v239, v222, v223
    v_mfma_f32_32x32x16_bf16 v[208:223], v[56:59], v[48:51], 0
    v_exp_f32 v192, v192
    v_exp_f32 v193, v193
    v_exp_f32 v194, v194
    v_mfma_f32_32x32x16_bf16 v[208:223], v[60:63], v[52:55], v[208:223]
    v_exp_f32 v195, v195
    v_exp_f32 v196, v196
    v_exp_f32 v197, v197
    v_mfma_f32_32x32x16_bf16 v[144:159], v[64:67], v[232:235], v[144:159]
    v_exp_f32 v198, v198
    v_exp_f32 v199, v199
    v_exp_f32 v200, v200
    v_mfma_f32_32x32x16_bf16 v[144:159], v[68:71], v[236:239], v[144:159]
    v_exp_f32 v201, v201
    v_exp_f32 v202, v202
    v_exp_f32 v203, v203
    v_exp_f32 v204, v204
    v_exp_f32 v205, v205
    v_exp_f32 v206, v206
    v_exp_f32 v207, v207
    v_cvt_pk_bf16_f32 v224, v192, v193
    v_cvt_pk_bf16_f32 v225, v194, v195
    v_cvt_pk_bf16_f32 v226, v196, v197
    v_cvt_pk_bf16_f32 v227, v198, v199
    v_cvt_pk_bf16_f32 v228, v200, v201
    v_cvt_pk_bf16_f32 v229, v202, v203
    v_cvt_pk_bf16_f32 v230, v204, v205
    v_cvt_pk_bf16_f32 v231, v206, v207
    s_waitcnt vmcnt(8)
    v_mfma_f32_32x32x16_bf16 v[192:207], v[72:75], v[24:27], 0
    v_exp_f32 v208, v208
    v_exp_f32 v209, v209
    v_exp_f32 v210, v210
    v_mfma_f32_32x32x16_bf16 v[192:207], v[76:79], v[28:31], v[192:207]
    v_exp_f32 v211, v211
    v_exp_f32 v212, v212
    v_exp_f32 v213, v213
    v_mfma_f32_32x32x16_bf16 v[160:175], v[64:67], v[224:227], v[160:175]
    v_exp_f32 v214, v214
    v_exp_f32 v215, v215
    v_exp_f32 v216, v216
    v_mfma_f32_32x32x16_bf16 v[160:175], v[68:71], v[228:231], v[160:175]
    v_exp_f32 v217, v217
    v_exp_f32 v218, v218
    v_exp_f32 v219, v219
    v_exp_f32 v220, v220
    v_exp_f32 v221, v221
    v_exp_f32 v222, v222
    v_exp_f32 v223, v223
    v_cvt_pk_bf16_f32 v232, v208, v209
    v_cvt_pk_bf16_f32 v233, v210, v211
    v_cvt_pk_bf16_f32 v234, v212, v213
    v_cvt_pk_bf16_f32 v235, v214, v215
    v_cvt_pk_bf16_f32 v236, v216, v217
    v_cvt_pk_bf16_f32 v237, v218, v219
    v_cvt_pk_bf16_f32 v238, v220, v221
    v_cvt_pk_bf16_f32 v239, v222, v223
    v_mfma_f32_32x32x16_bf16 v[208:223], v[72:75], v[32:35], 0
    v_exp_f32 v192, v192
    v_exp_f32 v193, v193
    v_exp_f32 v194, v194
    v_mfma_f32_32x32x16_bf16 v[208:223], v[76:79], v[36:39], v[208:223]
    v_exp_f32 v195, v195
    v_exp_f32 v196, v196
    v_exp_f32 v197, v197
    v_mfma_f32_32x32x16_bf16 v[176:191], v[64:67], v[232:235], v[176:191]
    v_exp_f32 v198, v198
    v_exp_f32 v199, v199
    v_exp_f32 v200, v200
    v_mfma_f32_32x32x16_bf16 v[176:191], v[68:71], v[236:239], v[176:191]
    v_exp_f32 v201, v201
    v_exp_f32 v202, v202
    v_exp_f32 v203, v203
    v_exp_f32 v204, v204
    v_exp_f32 v205, v205
    v_exp_f32 v206, v206
    v_exp_f32 v207, v207
    v_cvt_pk_bf16_f32 v224, v192, v193
    v_cvt_pk_bf16_f32 v225, v194, v195
    v_cvt_pk_bf16_f32 v226, v196, v197
    v_cvt_pk_bf16_f32 v227, v198, v199
    v_cvt_pk_bf16_f32 v228, v200, v201
    v_cvt_pk_bf16_f32 v229, v202, v203
    v_cvt_pk_bf16_f32 v230, v204, v205
    v_cvt_pk_bf16_f32 v231, v206, v207
    v_mfma_f32_32x32x16_bf16 v[192:207], v[72:75], v[40:43], 0
    v_exp_f32 v208, v208
    v_exp_f32 v209, v209
    v_exp_f32 v210, v210
    v_mfma_f32_32x32x16_bf16 v[192:207], v[76:79], v[44:47], v[192:207]
    v_exp_f32 v211, v211
    v_exp_f32 v212, v212
    v_exp_f32 v213, v213
    v_mfma_f32_32x32x16_bf16 v[128:143], v[80:83], v[224:227], v[128:143]
    v_exp_f32 v214, v214
    v_exp_f32 v215, v215
    v_exp_f32 v216, v216
    v_mfma_f32_32x32x16_bf16 v[128:143], v[84:87], v[228:231], v[128:143]
    v_exp_f32 v217, v217
    v_exp_f32 v218, v218
    v_exp_f32 v219, v219
    v_exp_f32 v220, v220
    v_exp_f32 v221, v221
    v_exp_f32 v222, v222
    v_exp_f32 v223, v223
    v_cvt_pk_bf16_f32 v232, v208, v209
    v_cvt_pk_bf16_f32 v233, v210, v211
    v_cvt_pk_bf16_f32 v234, v212, v213
    v_cvt_pk_bf16_f32 v235, v214, v215
    v_cvt_pk_bf16_f32 v236, v216, v217
    v_cvt_pk_bf16_f32 v237, v218, v219
    v_cvt_pk_bf16_f32 v238, v220, v221
    v_cvt_pk_bf16_f32 v239, v222, v223
    v_mfma_f32_32x32x16_bf16 v[208:223], v[72:75], v[48:51], 0
    v_exp_f32 v192, v192
    v_exp_f32 v193, v193
    v_exp_f32 v194, v194
    v_mfma_f32_32x32x16_bf16 v[208:223], v[76:79], v[52:55], v[208:223]
    v_exp_f32 v195, v195
    v_exp_f32 v196, v196
    v_exp_f32 v197, v197
    v_mfma_f32_32x32x16_bf16 v[144:159], v[80:83], v[232:235], v[144:159]
    v_exp_f32 v198, v198
    v_exp_f32 v199, v199
    v_exp_f32 v200, v200
    v_mfma_f32_32x32x16_bf16 v[144:159], v[84:87], v[236:239], v[144:159]
    v_exp_f32 v201, v201
    v_exp_f32 v202, v202
    v_exp_f32 v203, v203
    v_exp_f32 v204, v204
    v_exp_f32 v205, v205
    v_exp_f32 v206, v206
    v_exp_f32 v207, v207
    v_cvt_pk_bf16_f32 v224, v192, v193
    v_cvt_pk_bf16_f32 v225, v194, v195
    v_cvt_pk_bf16_f32 v226, v196, v197
    v_cvt_pk_bf16_f32 v227, v198, v199
    v_cvt_pk_bf16_f32 v228, v200, v201
    v_cvt_pk_bf16_f32 v229, v202, v203
    v_cvt_pk_bf16_f32 v230, v204, v205
    v_cvt_pk_bf16_f32 v231, v206, v207
    s_waitcnt vmcnt(4)
    v_mfma_f32_32x32x16_bf16 v[192:207], v[88:91], v[24:27], 0
    v_exp_f32 v208, v208
    v_exp_f32 v209, v209
    v_exp_f32 v210, v210
    v_mfma_f32_32x32x16_bf16 v[192:207], v[92:95], v[28:31], v[192:207]
    v_exp_f32 v211, v211
    v_exp_f32 v212, v212
    v_exp_f32 v213, v213
    v_mfma_f32_32x32x16_bf16 v[160:175], v[80:83], v[224:227], v[160:175]
    v_exp_f32 v214, v214
    v_exp_f32 v215, v215
    v_exp_f32 v216, v216
    v_mfma_f32_32x32x16_bf16 v[160:175], v[84:87], v[228:231], v[160:175]
    v_exp_f32 v217, v217
    v_exp_f32 v218, v218
    v_exp_f32 v219, v219
    v_exp_f32 v220, v220
    v_exp_f32 v221, v221
    v_exp_f32 v222, v222
    v_exp_f32 v223, v223
    v_cvt_pk_bf16_f32 v232, v208, v209
    v_cvt_pk_bf16_f32 v233, v210, v211
    v_cvt_pk_bf16_f32 v234, v212, v213
    v_cvt_pk_bf16_f32 v235, v214, v215
    v_cvt_pk_bf16_f32 v236, v216, v217
    v_cvt_pk_bf16_f32 v237, v218, v219
    v_cvt_pk_bf16_f32 v238, v220, v221
    v_cvt_pk_bf16_f32 v239, v222, v223
    v_mfma_f32_32x32x16_bf16 v[208:223], v[88:91], v[32:35], 0
    v_exp_f32 v192, v192
    v_exp_f32 v193, v193
    v_exp_f32 v194, v194
    v_mfma_f32_32x32x16_bf16 v[208:223], v[92:95], v[36:39], v[208:223]
    v_exp_f32 v195, v195
    v_exp_f32 v196, v196
    v_exp_f32 v197, v197
    v_mfma_f32_32x32x16_bf16 v[176:191], v[80:83], v[232:235], v[176:191]
    v_exp_f32 v198, v198
    v_exp_f32 v199, v199
    v_exp_f32 v200, v200
    v_mfma_f32_32x32x16_bf16 v[176:191], v[84:87], v[236:239], v[176:191]
    v_exp_f32 v201, v201
    v_exp_f32 v202, v202
    v_exp_f32 v203, v203
    v_exp_f32 v204, v204
    v_exp_f32 v205, v205
    v_exp_f32 v206, v206
    v_exp_f32 v207, v207
    v_cvt_pk_bf16_f32 v224, v192, v193
    v_cvt_pk_bf16_f32 v225, v194, v195
    v_cvt_pk_bf16_f32 v226, v196, v197
    v_cvt_pk_bf16_f32 v227, v198, v199
    v_cvt_pk_bf16_f32 v228, v200, v201
    v_cvt_pk_bf16_f32 v229, v202, v203
    v_cvt_pk_bf16_f32 v230, v204, v205
    v_cvt_pk_bf16_f32 v231, v206, v207
    v_mfma_f32_32x32x16_bf16 v[192:207], v[88:91], v[40:43], 0
    v_exp_f32 v208, v208
    v_exp_f32 v209, v209
    v_exp_f32 v210, v210
    v_mfma_f32_32x32x16_bf16 v[192:207], v[92:95], v[44:47], v[192:207]
    v_exp_f32 v211, v211
    v_exp_f32 v212, v212
    v_exp_f32 v213, v213
    v_mfma_f32_32x32x16_bf16 v[128:143], v[96:99], v[224:227], v[128:143]
    v_exp_f32 v214, v214
    v_exp_f32 v215, v215
    v_exp_f32 v216, v216
    v_mfma_f32_32x32x16_bf16 v[128:143], v[100:103], v[228:231], v[128:143]
    v_exp_f32 v217, v217
    v_exp_f32 v218, v218
    v_exp_f32 v219, v219
    v_exp_f32 v220, v220
    v_exp_f32 v221, v221
    v_exp_f32 v222, v222
    v_exp_f32 v223, v223
    v_cvt_pk_bf16_f32 v232, v208, v209
    v_cvt_pk_bf16_f32 v233, v210, v211
    v_cvt_pk_bf16_f32 v234, v212, v213
    v_cvt_pk_bf16_f32 v235, v214, v215
    v_cvt_pk_bf16_f32 v236, v216, v217
    v_cvt_pk_bf16_f32 v237, v218, v219
    v_cvt_pk_bf16_f32 v238, v220, v221
    v_cvt_pk_bf16_f32 v239, v222, v223
    v_mfma_f32_32x32x16_bf16 v[208:223], v[88:91], v[48:51], 0
    v_exp_f32 v192, v192
    v_exp_f32 v193, v193
    v_exp_f32 v194, v194
    v_mfma_f32_32x32x16_bf16 v[208:223], v[92:95], v[52:55], v[208:223]
    v_exp_f32 v195, v195
    v_exp_f32 v196, v196
    v_exp_f32 v197, v197
    v_mfma_f32_32x32x16_bf16 v[144:159], v[96:99], v[232:235], v[144:159]
    v_exp_f32 v198, v198
    v_exp_f32 v199, v199
    v_exp_f32 v200, v200
    v_mfma_f32_32x32x16_bf16 v[144:159], v[100:103], v[236:239], v[144:159]
    v_exp_f32 v201, v201
    v_exp_f32 v202, v202
    v_exp_f32 v203, v203
    v_exp_f32 v204, v204
    v_exp_f32 v205, v205
    v_exp_f32 v206, v206
    v_exp_f32 v207, v207
    v_cvt_pk_bf16_f32 v224, v192, v193
    v_cvt_pk_bf16_f32 v225, v194, v195
    v_cvt_pk_bf16_f32 v226, v196, v197
    v_cvt_pk_bf16_f32 v227, v198, v199
    v_cvt_pk_bf16_f32 v228, v200, v201
    v_cvt_pk_bf16_f32 v229, v202, v203
    v_cvt_pk_bf16_f32 v230, v204, v205
    v_cvt_pk_bf16_f32 v231, v206, v207
    s_waitcnt vmcnt(0)
    v_mfma_f32_32x32x16_bf16 v[192:207], v[104:107], v[32:35], 0
    v_exp_f32 v208, v208
    v_exp_f32 v209, v209
    v_exp_f32 v210, v210
    v_mfma_f32_32x32x16_bf16 v[192:207], v[108:111], v[36:39], v[192:207]
    v_exp_f32 v211, v211
    v_exp_f32 v212, v212
    v_exp_f32 v213, v213
    v_mfma_f32_32x32x16_bf16 v[160:175], v[96:99], v[224:227], v[160:175]
    v_exp_f32 v214, v214
    v_exp_f32 v215, v215
    v_exp_f32 v216, v216
    v_mfma_f32_32x32x16_bf16 v[160:175], v[100:103], v[228:231], v[160:175]
    v_exp_f32 v217, v217
    v_exp_f32 v218, v218
    v_exp_f32 v219, v219
    v_mov_b32 v244, 163584
    ds_read_b32 v245, v244
    v_exp_f32 v220, v220
    v_exp_f32 v221, v221
    v_exp_f32 v222, v222
    v_exp_f32 v223, v223
    v_cvt_pk_bf16_f32 v232, v208, v209
    v_cvt_pk_bf16_f32 v233, v210, v211
    v_cvt_pk_bf16_f32 v234, v212, v213
    v_cvt_pk_bf16_f32 v235, v214, v215
    v_cvt_pk_bf16_f32 v236, v216, v217
    v_cvt_pk_bf16_f32 v237, v218, v219
    v_cvt_pk_bf16_f32 v238, v220, v221
    v_cvt_pk_bf16_f32 v239, v222, v223
    v_mfma_f32_32x32x16_bf16 v[208:223], v[104:107], v[40:43], 0
    v_exp_f32 v192, v192
    v_exp_f32 v193, v193
    v_exp_f32 v194, v194
    v_mfma_f32_32x32x16_bf16 v[208:223], v[108:111], v[44:47], v[208:223]
    v_exp_f32 v195, v195
    v_exp_f32 v196, v196
    v_exp_f32 v197, v197
    v_mfma_f32_32x32x16_bf16 v[176:191], v[96:99], v[232:235], v[176:191]
    v_exp_f32 v198, v198
    v_exp_f32 v199, v199
    v_exp_f32 v200, v200
    v_mfma_f32_32x32x16_bf16 v[176:191], v[100:103], v[236:239], v[176:191]
    v_exp_f32 v201, v201
    v_exp_f32 v202, v202
    v_exp_f32 v203, v203
    v_exp_f32 v204, v204
    v_exp_f32 v205, v205
    v_exp_f32 v206, v206
    v_exp_f32 v207, v207
    v_cvt_pk_bf16_f32 v224, v192, v193
    v_cvt_pk_bf16_f32 v225, v194, v195
    v_cvt_pk_bf16_f32 v226, v196, v197
    v_cvt_pk_bf16_f32 v227, v198, v199
    v_cvt_pk_bf16_f32 v228, v200, v201
    v_cvt_pk_bf16_f32 v229, v202, v203
    v_cvt_pk_bf16_f32 v230, v204, v205
    v_cvt_pk_bf16_f32 v231, v206, v207
    v_mfma_f32_32x32x16_bf16 v[192:207], v[104:107], v[48:51], 0
    v_exp_f32 v208, v208
    v_exp_f32 v209, v209
    v_exp_f32 v210, v210
    v_mfma_f32_32x32x16_bf16 v[192:207], v[108:111], v[52:55], v[192:207]
    v_exp_f32 v211, v211
    v_exp_f32 v212, v212
    v_exp_f32 v213, v213
    v_mfma_f32_32x32x16_bf16 v[144:159], v[112:115], v[224:227], v[144:159]
    v_exp_f32 v214, v214
    v_exp_f32 v215, v215
    v_exp_f32 v216, v216
    v_mfma_f32_32x32x16_bf16 v[144:159], v[116:119], v[228:231], v[144:159]
    v_exp_f32 v217, v217
    v_exp_f32 v218, v218
    v_exp_f32 v219, v219
    v_exp_f32 v220, v220
    v_exp_f32 v221, v221
    v_exp_f32 v222, v222
    v_exp_f32 v223, v223
    v_cvt_pk_bf16_f32 v232, v208, v209
    v_cvt_pk_bf16_f32 v233, v210, v211
    v_cvt_pk_bf16_f32 v234, v212, v213
    v_cvt_pk_bf16_f32 v235, v214, v215
    v_cvt_pk_bf16_f32 v236, v216, v217
    v_cvt_pk_bf16_f32 v237, v218, v219
    v_cvt_pk_bf16_f32 v238, v220, v221
    v_cvt_pk_bf16_f32 v239, v222, v223
    v_mfma_f32_32x32x16_bf16 v[208:223], v[104:107], v[24:27], 0
    v_exp_f32 v192, v192
    v_exp_f32 v193, v193
    v_exp_f32 v194, v194
    v_mfma_f32_32x32x16_bf16 v[208:223], v[108:111], v[28:31], v[208:223]
    v_exp_f32 v195, v195
    v_exp_f32 v196, v196
    v_exp_f32 v197, v197
    v_mfma_f32_32x32x16_bf16 v[160:175], v[112:115], v[232:235], v[160:175]
    v_exp_f32 v198, v198
    v_exp_f32 v199, v199
    v_exp_f32 v200, v200
    v_mfma_f32_32x32x16_bf16 v[160:175], v[116:119], v[236:239], v[160:175]
    v_exp_f32 v201, v201
    v_exp_f32 v202, v202
    v_exp_f32 v203, v203
    s_mov_b32 s69, 0x400000
L_lc92:
    s_waitcnt lgkmcnt(0)
    v_readfirstlane_b32 s68, v245
    s_nop 0
    s_cmp_ge_u32 s68, 8
    s_cbranch_scc1 L_ld93
    ds_read_b32 v245, v244
    s_sub_u32 s69, s69, 1
    s_cbranch_scc0 L_lc92
L_ld93:
    ds_write_b128 v241, v[144:147] offset:0
    ds_write_b128 v241, v[148:151] offset:1024
    ds_write_b128 v241, v[152:155] offset:2048
    ds_write_b128 v241, v[156:159] offset:3072
    v_exp_f32 v204, v204
    v_exp_f32 v205, v205
    v_exp_f32 v206, v206
    v_exp_f32 v207, v207
    v_cvt_pk_bf16_f32 v224, v192, v193
    v_cvt_pk_bf16_f32 v225, v194, v195
    v_cvt_pk_bf16_f32 v226, v196, v197
    v_cvt_pk_bf16_f32 v227, v198, v199
    v_cvt_pk_bf16_f32 v228, v200, v201
    v_cvt_pk_bf16_f32 v229, v202, v203
    v_cvt_pk_bf16_f32 v230, v204, v205
    v_cvt_pk_bf16_f32 v231, v206, v207
    v_exp_f32 v208, v208
    v_exp_f32 v209, v209
    v_exp_f32 v210, v210
    v_exp_f32 v211, v211
    v_exp_f32 v212, v212
    v_exp_f32 v213, v213
    v_mfma_f32_32x32x16_bf16 v[176:191], v[112:115], v[224:227], v[176:191]
    v_exp_f32 v214, v214
    v_exp_f32 v215, v215
    v_exp_f32 v216, v216
    v_mfma_f32_32x32x16_bf16 v[176:191], v[116:119], v[228:231], v[176:191]
    v_exp_f32 v217, v217
    v_exp_f32 v218, v218
    v_exp_f32 v219, v219
    ds_write_b128 v242, v[160:163] offset:4096
    ds_write_b128 v242, v[164:167] offset:5120
    ds_write_b128 v242, v[168:171] offset:6144
    ds_write_b128 v242, v[172:175] offset:7168
    v_exp_f32 v220, v220
    v_exp_f32 v221, v221
    v_exp_f32 v222, v222
    v_exp_f32 v223, v223
    v_cvt_pk_bf16_f32 v232, v208, v209
    v_cvt_pk_bf16_f32 v233, v210, v211
    v_cvt_pk_bf16_f32 v234, v212, v213
    v_cvt_pk_bf16_f32 v235, v214, v215
    v_cvt_pk_bf16_f32 v236, v216, v217
    v_cvt_pk_bf16_f32 v237, v218, v219
    v_cvt_pk_bf16_f32 v238, v220, v221
    v_cvt_pk_bf16_f32 v239, v222, v223
    v_mfma_f32_32x32x16_bf16 v[128:143], v[112:115], v[232:235], v[128:143]
    s_nop 0
    v_mfma_f32_32x32x16_bf16 v[128:143], v[116:119], v[236:239], v[128:143]
    ds_write_b128 v243, v[176:179] offset:8192
    ds_write_b128 v243, v[180:183] offset:9216
    ds_write_b128 v243, v[184:187] offset:10240
    ds_write_b128 v243, v[188:191] offset:11264
    s_waitcnt lgkmcnt(0)
    v_mov_b32 v244, 163612
    v_mov_b32 v245, 1
    s_mov_b64 exec, 1
    ds_add_u32 v244, v245
    s_mov_b64 exec, -1
    s_mov_b32 s69, 0x400000
L_ls94:
    ds_read_b32 v245, v244
    s_waitcnt lgkmcnt(0)
    v_readfirstlane_b32 s68, v245
    s_sub_u32 s69, s69, 1
    s_cselect_b32 s68, 4, s68
    s_cmp_lt_u32 s68, 4
    s_cbranch_scc1 L_ls94
    ds_read_b128 v[144:147], v240 offset:0
    ds_read_b128 v[148:151], v240 offset:1024
    ds_read_b128 v[152:155], v240 offset:2048
    ds_read_b128 v[156:159], v240 offset:3072
    ds_read_b128 v[160:163], v240 offset:4096
    ds_read_b128 v[164:167], v240 offset:5120
    ds_read_b128 v[168:171], v240 offset:6144
    ds_read_b128 v[172:175], v240 offset:7168
    ds_read_b128 v[176:179], v240 offset:8192
    ds_read_b128 v[180:183], v240 offset:9216
    ds_read_b128 v[184:187], v240 offset:10240
    ds_read_b128 v[188:191], v240 offset:11264
    s_waitcnt lgkmcnt(8)
    v_add_f32 v128, v128, v144
    v_add_f32 v129, v129, v145
    v_add_f32 v130, v130, v146
    v_add_f32 v131, v131, v147
    v_add_f32 v132, v132, v148
    v_add_f32 v133, v133, v149
    v_add_f32 v134, v134, v150
    v_add_f32 v135, v135, v151
    v_add_f32 v136, v136, v152
    v_add_f32 v137, v137, v153
    v_add_f32 v138, v138, v154
    v_add_f32 v139, v139, v155
    v_add_f32 v140, v140, v156
    v_add_f32 v141, v141, v157
    v_add_f32 v142, v142, v158
    v_add_f32 v143, v143, v159
    s_waitcnt lgkmcnt(4)
    v_add_f32 v128, v128, v160
    v_add_f32 v129, v129, v161
    v_add_f32 v130, v130, v162
    v_add_f32 v131, v131, v163
    v_add_f32 v132, v132, v164
    v_add_f32 v133, v133, v165
    v_add_f32 v134, v134, v166
    v_add_f32 v135, v135, v167
    v_add_f32 v136, v136, v168
    v_add_f32 v137, v137, v169
    v_add_f32 v138, v138, v170
    v_add_f32 v139, v139, v171
    v_add_f32 v140, v140, v172
    v_add_f32 v141, v141, v173
    v_add_f32 v142, v142, v174
    v_add_f32 v143, v143, v175
    s_waitcnt lgkmcnt(0)
    v_add_f32 v128, v128, v176
    v_add_f32 v129, v129, v177
    v_add_f32 v130, v130, v178
    v_add_f32 v131, v131, v179
    v_add_f32 v132, v132, v180
    v_add_f32 v133, v133, v181
    v_add_f32 v134, v134, v182
    v_add_f32 v135, v135, v183
    v_add_f32 v136, v136, v184
    v_add_f32 v137, v137, v185
    v_add_f32 v138, v138, v186
    v_add_f32 v139, v139, v187
    v_add_f32 v140, v140, v188
    v_add_f32 v141, v141, v189
    v_add_f32 v142, v142, v190
    v_add_f32 v143, v143, v191
L_norm:
    v_mov_b32 v240, v140
    v_mov_b32 v241, v140
    s_nop 1
    v_permlane32_swap_b32 v240, v241
    v_rcp_f32 v240, v241
    v_mov_b32 v242, 0
    v_mul_f32 v128, v128, v240
    v_mul_f32 v129, v129, v240
    v_mul_f32 v130, v130, v240
    v_mul_f32 v131, v131, v240
    v_mul_f32 v132, v132, v240
    v_mul_f32 v133, v133, v240
    v_mul_f32 v134, v134, v240
    v_mul_f32 v135, v135, v240
    v_mul_f32 v136, v136, v240
    v_mul_f32 v137, v137, v240
    v_mul_f32 v138, v138, v240
    v_mul_f32 v139, v139, v240
    v_mul_f32 v140, v140, v240
    v_mul_f32 v141, v141, v240
    v_mul_f32 v142, v142, v240
    v_mul_f32 v143, v143, v240
    v_cvt_pk_bf16_f32 v224, v128, v129
    v_cvt_pk_bf16_f32 v225, v130, v131
    v_cvt_pk_bf16_f32 v226, v132, v133
    v_cvt_pk_bf16_f32 v227, v134, v135
    v_cvt_pk_bf16_f32 v228, v136, v137
    v_cvt_pk_bf16_f32 v229, v138, v139
    v_cvt_pk_bf16_f32 v230, v140, v141
    v_cvt_pk_bf16_f32 v231, v142, v143
    v_cndmask_b32 v230, 0, v230, vcc
    v_cndmask_b32 v231, 0, v231, vcc
    buffer_store_dwordx4 v[224:227], v2, s[44:47], s61 offen sc1
    buffer_store_dwordx4 v[228:231], v2, s[44:47], s61 offen offset:1024 sc1
    v_fmac_f32 v242, 0, v128
    v_fmac_f32 v242, 0, v129
    v_fmac_f32 v242, 0, v130
    v_fmac_f32 v242, 0, v131
    v_fmac_f32 v242, 0, v132
    v_fmac_f32 v242, 0, v133
    v_fmac_f32 v242, 0, v134
    v_fmac_f32 v242, 0, v135
    v_fmac_f32 v242, 0, v136
    v_fmac_f32 v242, 0, v137
    v_fmac_f32 v242, 0, v138
    v_fmac_f32 v242, 0, v139
    v_fmac_f32 v242, 0, v140
    v_fmac_f32 v242, 0, v141
    v_fmac_f32 v242, 0, v142
    v_fmac_f32 v242, 0, v143
    v_mov_b32 v243, 0x1b800000
    v_cmp_u_f32 s[66:67], v242, v242
    v_cmp_lt_f32 s[74:75], v241, v243
    s_nop 0
    s_or_b64 s[66:67], s[66:67], s[74:75]
    s_cmp_eq_u64 s[66:67], 0
    s_cselect_b32 s68, 1, s59
    s_cmp_eq_u32 s68, 0
    s_cbranch_scc1 L_slow
    s_waitcnt vmcnt(0)
    s_lshl2_add_u32 s69, s63, s48
    s_lshr_b32 s70, s62, 2
    s_lshl2_add_u32 s69, s69, s70
    s_add_u32 s68, s69, 28
    s_lshl_b32 s68, s68, 7
    s_add_u32 s68, s68, 18350080
    v_mov_b32 v244, 0
    v_mov_b32 v245, 1
    s_mov_b64 exec, 1
    buffer_atomic_add v245, v244, s[44:47], s68 offen sc1
    s_mov_b64 exec, -1
    s_endpgm
L_slow:
    s_waitcnt vmcnt(0)
    s_mov_b32 s59, 1
    s_mov_b32 s38, 0x20000
    s_mov_b32 s42, 0x20000
    v_cndmask_b32 v30, 0, v30, vcc
    v_cndmask_b32 v31, 0, v31, vcc
    v_mov_b32 v248, 0xff800000
    s_mov_b32 s58, 0
    s_mov_b32 s60, 64
L_s1:
    buffer_load_dwordx4 v[56:59], v2, s[36:39], s58 offen sc1
    buffer_load_dwordx4 v[60:63], v2, s[36:39], s58 offen offset:1024 sc1
    s_waitcnt vmcnt(0)
    v_mfma_f32_32x32x16_bf16 v[192:207], v[56:59], v[24:27], 0
    v_mfma_f32_32x32x16_bf16 v[192:207], v[60:63], v[28:31], v[192:207]
    s_nop 11
    v_max3_f32 v248, v248, v192, v193
    v_max3_f32 v248, v248, v194, v195
    v_max3_f32 v248, v248, v196, v197
    v_max3_f32 v248, v248, v198, v199
    v_max3_f32 v248, v248, v200, v201
    v_max3_f32 v248, v248, v202, v203
    v_max3_f32 v248, v248, v204, v205
    v_max3_f32 v248, v248, v206, v207
    s_add_u32 s58, s58, 2048
    s_sub_u32 s60, s60, 1
    s_cmp_lg_u32 s60, 0
    s_cbranch_scc1 L_s1
    v_mov_b32 v252, v248
    s_nop 1
    v_permlane32_swap_b32 v248, v252
    v_max_f32 v248, v248, v252
    v_sub_f32 v248, 0, v248
    v_cvt_pk_bf16_f32 v252, v248, v248
    v_and_b32 v252, 0xffff0000, v252
    v_sub_f32 v252, v248, v252
    v_cvt_pk_bf16_f32 v248, v248, v252
    v_cndmask_b32 v30, v248, v30, vcc
    v_and_b32 v248, 0xffff0000, v248
    v_sub_f32 v252, v252, v248
    v_cvt_pk_bf16_f32 v252, v252, 0
    v_cndmask_b32 v31, v252, v31, vcc
    v_mov_b32 v128, 0
    v_mov_b32 v129, 0
    v_mov_b32 v130, 0
    v_mov_b32 v131, 0
    v_mov_b32 v132, 0
    v_mov_b32 v133, 0
    v_mov_b32 v134, 0
    v_mov_b32 v135, 0
    v_mov_b32 v136, 0
    v_mov_b32 v137, 0
    v_mov_b32 v138, 0
    v_mov_b32 v139, 0
    v_mov_b32 v140, 0
    v_mov_b32 v141, 0
    v_mov_b32 v142, 0
    v_mov_b32 v143, 0
    s_mov_b32 s58, 0
    s_mov_b32 s60, 64
L_s2:
    buffer_load_dwordx4 v[56:59], v2, s[36:39], s58 offen offset:0 sc1
    buffer_load_dwordx4 v[60:63], v2, s[36:39], s58 offen offset:1024 sc1
    buffer_load_dwordx4 v[64:67], v2, s[40:43], s58 offen offset:0 sc1
    buffer_load_dwordx4 v[68:71], v2, s[40:43], s58 offen offset:1024 sc1
    s_waitcnt vmcnt(0)
    v_mfma_f32_32x32x16_bf16 v[192:207], v[56:59], v[24:27], 0
    v_mfma_f32_32x32x16_bf16 v[192:207], v[60:63], v[28:31], v[192:207]
    s_nop 11
    v_exp_f32 v192, v192
    v_exp_f32 v193, v193
    v_exp_f32 v194, v194
    v_exp_f32 v195, v195
    v_cvt_pk_bf16_f32 v224, v192, v193
    v_cvt_pk_bf16_f32 v225, v194, v195
    v_exp_f32 v196, v196
    v_exp_f32 v197, v197
    v_exp_f32 v198, v198
    v_exp_f32 v199, v199
    v_cvt_pk_bf16_f32 v226, v196, v197
    v_cvt_pk_bf16_f32 v227, v198, v199
    v_exp_f32 v200, v200
    v_exp_f32 v201, v201
    v_exp_f32 v202, v202
    v_exp_f32 v203, v203
    v_cvt_pk_bf16_f32 v228, v200, v201
    v_cvt_pk_bf16_f32 v229, v202, v203
    v_exp_f32 v204, v204
    v_exp_f32 v205, v205
    v_exp_f32 v206, v206
    v_exp_f32 v207, v207
    v_cvt_pk_bf16_f32 v230, v204, v205
    v_cvt_pk_bf16_f32 v231, v206, v207
    v_mfma_f32_32x32x16_bf16 v[128:143], v[64:67], v[224:227], v[128:143]
    s_nop 0
    v_mfma_f32_32x32x16_bf16 v[128:143], v[68:71], v[228:231], v[128:143]
    s_add_u32 s58, s58, 2048
    s_sub_u32 s60, s60, 1
    s_cmp_lg_u32 s60, 0
    s_nop 11
    s_cbranch_scc1 L_s2
    s_branch L_norm
L_gemm:
    s_setprio 2
    s_cmp_lt_u32 s55, 28
    s_cbranch_scc1 L_gemm2
    s_waitcnt vmcnt(0)
    v_mov_b32 v152, 163584
    v_mov_b32 v153, 1
    s_mov_b64 exec, 1
    ds_add_rtn_u32 v153, v152, v153
    s_mov_b64 exec, -1
    s_waitcnt lgkmcnt(0)
    v_readfirstlane_b32 s68, v153
    s_nop 0
    s_cmp_lg_u32 s68, 7
    s_cbranch_scc1 L_ns95
    s_add_u32 s68, s51, 12
    s_lshl_b32 s68, s68, 7
    s_add_u32 s68, s68, 18350080
    v_mov_b32 v152, 0
    v_mov_b32 v153, 1
    s_mov_b64 exec, 1
    buffer_atomic_add v153, v152, s[44:47], s68 offen sc1
    s_mov_b64 exec, -1
L_ns95:
    s_endpgm
L_gemm2:
    s_waitcnt lgkmcnt(0)
    v_mov_b32 v152, 163596
    v_mov_b32 v153, 1
    s_mov_b64 exec, 1
    ds_add_u32 v152, v153
    s_mov_b64 exec, -1
    s_mov_b32 s69, 0x400000
L_ls96:
    ds_read_b32 v153, v152
    s_waitcnt lgkmcnt(0)
    v_readfirstlane_b32 s68, v153
    s_sub_u32 s69, s69, 1
    s_cselect_b32 s68, 4, s68
    s_cmp_lt_u32 s68, 4
    s_cbranch_scc1 L_ls96
    s_mov_b32 s36, s8
    s_mov_b32 s37, s9
    s_mov_b32 s38, 0x62000
    s_mov_b32 s39, 0x20000
    s_sub_u32 s62, s48, 4
    s_mul_i32 s68, s55, 37
    s_lshr_b32 s68, s68, 8
    s_mul_i32 s69, s68, 7
    s_sub_u32 s64, s55, s69
    s_lshl2_add_u32 s63, s54, s68
    s_lshl_b32 s64, s64, 7
    s_mul_i32 s66, s62, 12288
    v_lshrrev_b32 v152, 4, v1
    v_and_b32 v152, 1, v152
    v_lshlrev_b32 v152, 2, v152
    v_and_b32 v153, 7, v1
    v_xor_b32 v152, v152, v153
    v_lshrrev_b32 v153, 3, v1
    v_mul_u32_u24 v153, 896, v153
    v_lshl_add_u32 v3, v152, 4, v153
    v_and_b32 v152, 31, v1
    v_mul_u32_u24 v152, 896, v152
    v_lshrrev_b32 v153, 5, v1
    v_lshl_add_u32 v6, v153, 3, v152
    s_and_b32 s68, s62, 1
    s_lshl1_add_u32 s70, s63, s68
    s_mul_i32 s61, s70, 28672
    s_add_u32 s61, s61, s64
    s_lshr_b32 s69, s62, 1
    s_lshl_b32 s69, s69, 6
    s_add_u32 s61, s61, s69
    s_mov_b32 s40, s16
    s_mov_b32 s41, s17
    s_mov_b32 s42, 0x188000
    s_mov_b32 s43, 0x20000
    s_mul_i32 s58, s62, 401408
    s_add_u32 s58, s58, s64
    s_add_u32 m0, s66, 0
    s_add_u32 s68, s58, 7168
    buffer_load_dwordx4 v3, s[40:43], s58 offen lds
    s_add_u32 m0, s66, 1024
    s_add_u32 s58, s58, 14336
    buffer_load_dwordx4 v3, s[40:43], s68 offen lds
    s_add_u32 m0, s66, 2048
    s_add_u32 s68, s58, 7168
    buffer_load_dwordx4 v3, s[40:43], s58 offen lds
    s_add_u32 m0, s66, 3072
    s_add_u32 s58, s58, 14336
    buffer_load_dwordx4 v3, s[40:43], s68 offen lds
    s_mul_i32 s59, s70, 112
    s_xor_b32 s70, s70, 1
    s_mul_i32 s60, s70, 112
    s_mul_i32 s68, s62, 28
    s_add_u32 s68, s68, 6144
    s_add_u32 s59, s59, s68
    s_add_u32 s60, s60, s68
    s_lshl_b32 s59, s59, 10
    s_lshl_b32 s60, s60, 10
    s_xor_b32 s69, s69, s66
    v_and_b32 v152, 15, v1
    v_lshrrev_b32 v153, 5, v1
    v_lshrrev_b32 v154, 2, v152
    v_lshl_add_u32 v153, v153, 2, v154
    v_lshlrev_b32 v153, 7, v153
    v_lshrrev_b32 v154, 3, v152
    v_lshl_add_u32 v153, v154, 6, v153
    v_and_b32 v152, 3, v152
    v_lshl_add_u32 v153, v152, 3, v153
    v_and_b32 v152, 16, v1
    v_lshl_add_u32 v153, v152, 1, v153
    v_xor_b32 v4, s69, v153
    v_xor_b32 v5, 64, v4
    s_lshr_b32 s68, s63, 1
    s_lshl_b32 s68, s68, 7
    s_add_u32 s68, s68, 1536
    v_mov_b32 v7, s68
    s_waitcnt vmcnt(4)
    v_mov_b32 v152, 163584
    v_mov_b32 v153, 1
    s_mov_b64 exec, 1
    ds_add_rtn_u32 v153, v152, v153
    s_mov_b64 exec, -1
    s_waitcnt lgkmcnt(0)
    v_readfirstlane_b32 s68, v153
    s_nop 0
    s_cmp_lg_u32 s68, 7
    s_cbranch_scc1 L_ns97
    s_add_u32 s68, s51, 12
    s_lshl_b32 s68, s68, 7
    s_add_u32 s68, s68, 18350080
    v_mov_b32 v152, 0
    v_mov_b32 v153, 1
    s_mov_b64 exec, 1
    buffer_atomic_add v153, v152, s[44:47], s68 offen sc1
    s_mov_b64 exec, -1
L_ns97:
    s_add_u32 m0, s66, 4096
    s_add_u32 s68, s58, 7168
    buffer_load_dwordx4 v3, s[40:43], s58 offen lds
    s_add_u32 m0, s66, 5120
    s_add_u32 s58, s58, 14336
    buffer_load_dwordx4 v3, s[40:43], s68 offen lds
    s_waitcnt vmcnt(4)
    s_add_u32 m0, s66, 6144
    s_add_u32 s68, s58, 7168
    buffer_load_dwordx4 v3, s[40:43], s58 offen lds
    s_add_u32 m0, s66, 7168
    s_add_u32 s58, s58, 14336
    buffer_load_dwordx4 v3, s[40:43], s68 offen lds
    s_waitcnt vmcnt(4)
    s_add_u32 m0, s66, 8192
    s_add_u32 s68, s58, 7168
    buffer_load_dwordx4 v3, s[40:43], s58 offen lds
    s_add_u32 m0, s66, 9216
    s_add_u32 s58, s58, 14336
    buffer_load_dwordx4 v3, s[40:43], s68 offen lds
    s_waitcnt vmcnt(4)
    s_add_u32 m0, s66, 10240
    s_add_u32 s68, s58, 7168
    buffer_load_dwordx4 v3, s[40:43], s58 offen lds
    s_add_u32 m0, s66, 11264
    s_add_u32 s58, s58, 14336
    buffer_load_dwordx4 v3, s[40:43], s68 offen lds
    s_waitcnt vmcnt(4)
    s_cmp_lg_u32 s62, 0
    s_cbranch_scc1 L_hw
    s_mov_b32 s69, 0x40000
    s_mov_b32 s70, 18350080
L_po98:
    buffer_load_dword v153, v7, s[44:47], s70 offen sc1
    s_waitcnt vmcnt(0)
    v_cmp_gt_u32 s[74:75], 16, v153
    s_nop 0
    s_cmp_eq_u64 s[74:75], 0
    s_cbranch_scc1 L_pd99
    s_sleep 4
    s_sub_u32 s69, s69, 1
    s_cbranch_scc0 L_po98
L_pd99:
    v_mov_b32 v152, 163616
    v_mov_b32 v153, 1
    s_mov_b64 exec, 1
    ds_add_u32 v152, v153
    s_mov_b64 exec, -1
L_hw:
    v_mov_b32 v152, 163592
    s_mov_b32 s69, 0x100000
L_ls100:
    ds_read_b32 v153, v152
    s_waitcnt lgkmcnt(0)
    v_readfirstlane_b32 s68, v153
    s_nop 0
    s_cmp_ge_u32 s68, 4
    s_cbranch_scc1 L_lk101
    s_sleep 3
    s_sub_u32 s69, s69, 1
    s_cbranch_scc0 L_ls100
L_lk101:
    v_mov_b32 v152, 163616
    s_mov_b32 s69, 0x100000
L_ls102:
    ds_read_b32 v153, v152
    s_waitcnt lgkmcnt(0)
    v_readfirstlane_b32 s68, v153
    s_nop 0
    s_cmp_ge_u32 s68, 1
    s_cbranch_scc1 L_lk103
    s_sleep 3
    s_sub_u32 s69, s69, 1
    s_cbranch_scc0 L_ls102
L_lk103:
    s_waitcnt vmcnt(0)
    buffer_load_dwordx4 v[80:83], v2, s[44:47], s59 offen offset:0 sc1
    buffer_load_dwordx4 v[84:87], v2, s[44:47], s60 offen offset:0 sc1
    buffer_load_dwordx4 v[88:91], v2, s[44:47], s59 offen offset:1024 sc1
    buffer_load_dwordx4 v[92:95], v2, s[44:47], s60 offen offset:1024 sc1
    buffer_load_dwordx4 v[96:99], v2, s[44:47], s59 offen offset:2048 sc1
    buffer_load_dwordx4 v[100:103], v2, s[44:47], s60 offen offset:2048 sc1
    buffer_load_dwordx4 v[104:107], v2, s[44:47], s59 offen offset:3072 sc1
    buffer_load_dwordx4 v[108:111], v2, s[44:47], s60 offen offset:3072 sc1
    s_add_u32 s59, s59, 4096
    s_add_u32 s60, s60, 4096
    buffer_load_dwordx4 v[112:115], v2, s[44:47], s59 offen offset:0 sc1
    buffer_load_dwordx4 v[116:119], v2, s[44:47], s60 offen offset:0 sc1
    s_setprio 0
    s_waitcnt vmcnt(8)
    ds_read_b64_tr_b16 v[136:137], v4 offset:0
    ds_read_b64_tr_b16 v[138:139], v4 offset:1024
    ds_read_b64_tr_b16 v[140:141], v5 offset:0
    ds_read_b64_tr_b16 v[142:143], v5 offset:1024
    s_waitcnt vmcnt(6)
    ds_read_b64_tr_b16 v[144:145], v4 offset:2048
    ds_read_b64_tr_b16 v[146:147], v4 offset:3072
    ds_read_b64_tr_b16 v[148:149], v5 offset:2048
    ds_read_b64_tr_b16 v[150:151], v5 offset:3072
    s_waitcnt lgkmcnt(4)
    v_mfma_f32_32x32x16_bf16 v[16:31], v[136:139], v[80:83], 0
    v_mfma_f32_32x32x16_bf16 v[32:47], v[136:139], v[84:87], 0
    v_mfma_f32_32x32x16_bf16 v[48:63], v[140:143], v[80:83], 0
    v_mfma_f32_32x32x16_bf16 v[64:79], v[140:143], v[84:87], 0
    buffer_load_dwordx4 v[120:123], v2, s[44:47], s59 offen offset:1024 sc1
    buffer_load_dwordx4 v[124:127], v2, s[44:47], s60 offen offset:1024 sc1
    s_waitcnt vmcnt(6)
    ds_read_b64_tr_b16 v[136:137], v4 offset:4096
    ds_read_b64_tr_b16 v[138:139], v4 offset:5120
    ds_read_b64_tr_b16 v[140:141], v5 offset:4096
    ds_read_b64_tr_b16 v[142:143], v5 offset:5120
    s_waitcnt lgkmcnt(4)
    v_mfma_f32_32x32x16_bf16 v[16:31], v[144:147], v[88:91], v[16:31]
    v_mfma_f32_32x32x16_bf16 v[32:47], v[144:147], v[92:95], v[32:47]
    v_mfma_f32_32x32x16_bf16 v[48:63], v[148:151], v[88:91], v[48:63]
    v_mfma_f32_32x32x16_bf16 v[64:79], v[148:151], v[92:95], v[64:79]
    s_add_u32 m0, s66, 0
    s_add_u32 s68, s58, 7168
    buffer_load_dwordx4 v3, s[40:43], s58 offen lds
    s_add_u32 m0, s66, 1024
    s_add_u32 s58, s58, 14336
    buffer_load_dwordx4 v3, s[40:43], s68 offen lds
    buffer_load_dwordx4 v[80:83], v2, s[44:47], s59 offen offset:2048 sc1
    buffer_load_dwordx4 v[84:87], v2, s[44:47], s60 offen offset:2048 sc1
    s_waitcnt vmcnt(8)
    ds_read_b64_tr_b16 v[144:145], v4 offset:6144
    ds_read_b64_tr_b16 v[146:147], v4 offset:7168
    ds_read_b64_tr_b16 v[148:149], v5 offset:6144
    ds_read_b64_tr_b16 v[150:151], v5 offset:7168
    s_waitcnt lgkmcnt(4)
    v_mfma_f32_32x32x16_bf16 v[16:31], v[136:139], v[96:99], v[16:31]
    v_mfma_f32_32x32x16_bf16 v[32:47], v[136:139], v[100:103], v[32:47]
    v_mfma_f32_32x32x16_bf16 v[48:63], v[140:143], v[96:99], v[48:63]
    v_mfma_f32_32x32x16_bf16 v[64:79], v[140:143], v[100:103], v[64:79]
    s_add_u32 m0, s66, 2048
    s_add_u32 s68, s58, 7168
    buffer_load_dwordx4 v3, s[40:43], s58 offen lds
    s_add_u32 m0, s66, 3072
    s_add_u32 s58, s58, 14336
    buffer_load_dwordx4 v3, s[40:43], s68 offen lds
    buffer_load_dwordx4 v[88:91], v2, s[44:47], s59 offen offset:3072 sc1
    buffer_load_dwordx4 v[92:95], v2, s[44:47], s60 offen offset:3072 sc1
    s_add_u32 s59, s59, 4096
    s_add_u32 s60, s60, 4096
    s_waitcnt vmcnt(10)
    ds_read_b64_tr_b16 v[136:137], v4 offset:8192
    ds_read_b64_tr_b16 v[138:139], v4 offset:9216
    ds_read_b64_tr_b16 v[140:141], v5 offset:8192
    ds_read_b64_tr_b16 v[142:143], v5 offset:9216
    s_waitcnt lgkmcnt(4)
    v_mfma_f32_32x32x16_bf16 v[16:31], v[144:147], v[104:107], v[16:31]
    v_mfma_f32_32x32x16_bf16 v[32:47], v[144:147], v[108:111], v[32:47]
    v_mfma_f32_32x32x16_bf16 v[48:63], v[148:151], v[104:107], v[48:63]
    v_mfma_f32_32x32x16_bf16 v[64:79], v[148:151], v[108:111], v[64:79]
    s_add_u32 m0, s66, 4096
    s_add_u32 s68, s58, 7168
    buffer_load_dwordx4 v3, s[40:43], s58 offen lds
    s_add_u32 m0, s66, 5120
    s_add_u32 s58, s58, 14336
    buffer_load_dwordx4 v3, s[40:43], s68 offen lds
    buffer_load_dwordx4 v[96:99], v2, s[44:47], s59 offen offset:0 sc1
    buffer_load_dwordx4 v[100:103], v2, s[44:47], s60 offen offset:0 sc1
    s_waitcnt vmcnt(12)
    ds_read_b64_tr_b16 v[144:145], v4 offset:10240
    ds_read_b64_tr_b16 v[146:147], v4 offset:11264
    ds_read_b64_tr_b16 v[148:149], v5 offset:10240
    ds_read_b64_tr_b16 v[150:151], v5 offset:11264
    s_waitcnt lgkmcnt(4)
    v_mfma_f32_32x32x16_bf16 v[16:31], v[136:139], v[112:115], v[16:31]
    v_mfma_f32_32x32x16_bf16 v[32:47], v[136:139], v[116:119], v[32:47]
    v_mfma_f32_32x32x16_bf16 v[48:63], v[140:143], v[112:115], v[48:63]
    v_mfma_f32_32x32x16_bf16 v[64:79], v[140:143], v[116:119], v[64:79]
    s_add_u32 m0, s66, 6144
    s_add_u32 s68, s58, 7168
    buffer_load_dwordx4 v3, s[40:43], s58 offen lds
    s_add_u32 m0, s66, 7168
    s_add_u32 s58, s58, 14336
    buffer_load_dwordx4 v3, s[40:43], s68 offen lds
    buffer_load_dwordx4 v[104:107], v2, s[44:47], s59 offen offset:1024 sc1
    buffer_load_dwordx4 v[108:111], v2, s[44:47], s60 offen offset:1024 sc1
    s_waitcnt vmcnt(12)
    ds_read_b64_tr_b16 v[136:137], v4 offset:0
    ds_read_b64_tr_b16 v[138:139], v4 offset:1024
    ds_read_b64_tr_b16 v[140:141], v5 offset:0
    ds_read_b64_tr_b16 v[142:143], v5 offset:1024
    s_waitcnt lgkmcnt(4)
    v_mfma_f32_32x32x16_bf16 v[16:31], v[144:147], v[120:123], v[16:31]
    v_mfma_f32_32x32x16_bf16 v[32:47], v[144:147], v[124:127], v[32:47]
    v_mfma_f32_32x32x16_bf16 v[48:63], v[148:151], v[120:123], v[48:63]
    v_mfma_f32_32x32x16_bf16 v[64:79], v[148:151], v[124:127], v[64:79]
    s_add_u32 m0, s66, 8192
    s_add_u32 s68, s58, 7168
    buffer_load_dwordx4 v3, s[40:43], s58 offen lds
    s_add_u32 m0, s66, 9216
    s_add_u32 s58, s58, 14336
    buffer_load_dwordx4 v3, s[40:43], s68 offen lds
    buffer_load_dwordx4 v[112:115], v2, s[44:47], s59 offen offset:2048 sc1
    buffer_load_dwordx4 v[116:119], v2, s[44:47], s60 offen offset:2048 sc1
    s_waitcnt vmcnt(12)
    ds_read_b64_tr_b16 v[144:145], v4 offset:2048
    ds_read_b64_tr_b16 v[146:147], v4 offset:3072
    ds_read_b64_tr_b16 v[148:149], v5 offset:2048
    ds_read_b64_tr_b16 v[150:151], v5 offset:3072
    s_waitcnt lgkmcnt(4)
    v_mfma_f32_32x32x16_bf16 v[16:31], v[136:139], v[80:83], v[16:31]
    v_mfma_f32_32x32x16_bf16 v[32:47], v[136:139], v[84:87], v[32:47]
    v_mfma_f32_32x32x16_bf16 v[48:63], v[140:143], v[80:83], v[48:63]
    v_mfma_f32_32x32x16_bf16 v[64:79], v[140:143], v[84:87], v[64:79]
    s_add_u32 m0, s66, 10240
    s_add_u32 s68, s58, 7168
    buffer_load_dwordx4 v3, s[40:43], s58 offen lds
    s_add_u32 m0, s66, 11264
    s_add_u32 s58, s58, 14336
    buffer_load_dwordx4 v3, s[40:43], s68 offen lds
    buffer_load_dwordx4 v[120:123], v2, s[44:47], s59 offen offset:3072 sc1
    buffer_load_dwordx4 v[124:127], v2, s[44:47], s60 offen offset:3072 sc1
    s_add_u32 s59, s59, 4096
    s_add_u32 s60, s60, 4096
    s_waitcnt vmcnt(12)
    ds_read_b64_tr_b16 v[136:137], v4 offset:4096
    ds_read_b64_tr_b16 v[138:139], v4 offset:5120
    ds_read_b64_tr_b16 v[140:141], v5 offset:4096
    ds_read_b64_tr_b16 v[142:143], v5 offset:5120
    s_waitcnt lgkmcnt(4)
    v_mfma_f32_32x32x16_bf16 v[16:31], v[144:147], v[88:91], v[16:31]
    v_mfma_f32_32x32x16_bf16 v[32:47], v[144:147], v[92:95], v[32:47]
    v_mfma_f32_32x32x16_bf16 v[48:63], v[148:151], v[88:91], v[48:63]
    v_mfma_f32_32x32x16_bf16 v[64:79], v[148:151], v[92:95], v[64:79]
    s_add_u32 m0, s66, 0
    s_add_u32 s68, s58, 7168
    buffer_load_dwordx4 v3, s[40:43], s58 offen lds
    s_add_u32 m0, s66, 1024
    s_add_u32 s58, s58, 14336
    buffer_load_dwordx4 v3, s[40:43], s68 offen lds
    buffer_load_dwordx4 v[80:83], v2, s[44:47], s59 offen offset:0 sc1
    buffer_load_dwordx4 v[84:87], v2, s[44:47], s60 offen offset:0 sc1
    s_waitcnt vmcnt(12)
    ds_read_b64_tr_b16 v[144:145], v4 offset:6144
    ds_read_b64_tr_b16 v[146:147], v4 offset:7168
    ds_read_b64_tr_b16 v[148:149], v5 offset:6144
    ds_read_b64_tr_b16 v[150:151], v5 offset:7168
    s_waitcnt lgkmcnt(4)
    v_mfma_f32_32x32x16_bf16 v[16:31], v[136:139], v[96:99], v[16:31]
    v_mfma_f32_32x32x16_bf16 v[32:47], v[136:139], v[100:103], v[32:47]
    v_mfma_f32_32x32x16_bf16 v[48:63], v[140:143], v[96:99], v[48:63]
    v_mfma_f32_32x32x16_bf16 v[64:79], v[140:143], v[100:103], v[64:79]
    s_add_u32 m0, s66, 2048
    s_add_u32 s68, s58, 7168
    buffer_load_dwordx4 v3, s[40:43], s58 offen lds
    s_add_u32 m0, s66, 3072
    s_add_u32 s58, s58, 14336
    buffer_load_dwordx4 v3, s[40:43], s68 offen lds
    buffer_load_dwordx4 v[88:91], v2, s[44:47], s59 offen offset:1024 sc1
    buffer_load_dwordx4 v[92:95], v2, s[44:47], s60 offen offset:1024 sc1
    s_waitcnt vmcnt(12)
    ds_read_b64_tr_b16 v[136:137], v4 offset:8192
    ds_read_b64_tr_b16 v[138:139], v4 offset:9216
    ds_read_b64_tr_b16 v[140:141], v5 offset:8192
    ds_read_b64_tr_b16 v[142:143], v5 offset:9216
    s_waitcnt lgkmcnt(4)
    v_mfma_f32_32x32x16_bf16 v[16:31], v[144:147], v[104:107], v[16:31]
    v_mfma_f32_32x32x16_bf16 v[32:47], v[144:147], v[108:111], v[32:47]
    v_mfma_f32_32x32x16_bf16 v[48:63], v[148:151], v[104:107], v[48:63]
    v_mfma_f32_32x32x16_bf16 v[64:79], v[148:151], v[108:111], v[64:79]
    s_add_u32 m0, s66, 4096
    s_add_u32 s68, s58, 7168
    buffer_load_dwordx4 v3, s[40:43], s58 offen lds
    s_add_u32 m0, s66, 5120
    s_add_u32 s58, s58, 14336
    buffer_load_dwordx4 v3, s[40:43], s68 offen lds
    buffer_load_dwordx4 v[96:99], v2, s[44:47], s59 offen offset:2048 sc1
    buffer_load_dwordx4 v[100:103], v2, s[44:47], s60 offen offset:2048 sc1
    s_waitcnt vmcnt(12)
    ds_read_b64_tr_b16 v[144:145], v4 offset:10240
    ds_read_b64_tr_b16 v[146:147], v4 offset:11264
    ds_read_b64_tr_b16 v[148:149], v5 offset:10240
    ds_read_b64_tr_b16 v[150:151], v5 offset:11264
    s_waitcnt lgkmcnt(4)
    v_mfma_f32_32x32x16_bf16 v[16:31], v[136:139], v[112:115], v[16:31]
    v_mfma_f32_32x32x16_bf16 v[32:47], v[136:139], v[116:119], v[32:47]
    v_mfma_f32_32x32x16_bf16 v[48:63], v[140:143], v[112:115], v[48:63]
    v_mfma_f32_32x32x16_bf16 v[64:79], v[140:143], v[116:119], v[64:79]
    s_add_u32 m0, s66, 6144
    s_add_u32 s68, s58, 7168
    buffer_load_dwordx4 v3, s[40:43], s58 offen lds
    s_add_u32 m0, s66, 7168
    s_add_u32 s58, s58, 14336
    buffer_load_dwordx4 v3, s[40:43], s68 offen lds
    buffer_load_dwordx4 v[104:107], v2, s[44:47], s59 offen offset:3072 sc1
    buffer_load_dwordx4 v[108:111], v2, s[44:47], s60 offen offset:3072 sc1
    s_add_u32 s59, s59, 4096
    s_add_u32 s60, s60, 4096
    s_waitcnt vmcnt(12)
    ds_read_b64_tr_b16 v[136:137], v4 offset:0
    ds_read_b64_tr_b16 v[138:139], v4 offset:1024
    ds_read_b64_tr_b16 v[140:141], v5 offset:0
    ds_read_b64_tr_b16 v[142:143], v5 offset:1024
    s_waitcnt lgkmcnt(4)
    v_mfma_f32_32x32x16_bf16 v[16:31], v[144:147], v[120:123], v[16:31]
    v_mfma_f32_32x32x16_bf16 v[32:47], v[144:147], v[124:127], v[32:47]
    v_mfma_f32_32x32x16_bf16 v[48:63], v[148:151], v[120:123], v[48:63]
    v_mfma_f32_32x32x16_bf16 v[64:79], v[148:151], v[124:127], v[64:79]
    s_add_u32 m0, s66, 8192
    s_add_u32 s68, s58, 7168
    buffer_load_dwordx4 v3, s[40:43], s58 offen lds
    s_add_u32 m0, s66, 9216
    s_add_u32 s58, s58, 14336
    buffer_load_dwordx4 v3, s[40:43], s68 offen lds
    buffer_load_dwordx4 v[112:115], v2, s[44:47], s59 offen offset:0 sc1
    buffer_load_dwordx4 v[116:119], v2, s[44:47], s60 offen offset:0 sc1
    s_waitcnt vmcnt(12)
    ds_read_b64_tr_b16 v[144:145], v4 offset:2048
    ds_read_b64_tr_b16 v[146:147], v4 offset:3072
    ds_read_b64_tr_b16 v[148:149], v5 offset:2048
    ds_read_b64_tr_b16 v[150:151], v5 offset:3072
    s_waitcnt lgkmcnt(4)
    v_mfma_f32_32x32x16_bf16 v[16:31], v[136:139], v[80:83], v[16:31]
    v_mfma_f32_32x32x16_bf16 v[32:47], v[136:139], v[84:87], v[32:47]
    v_mfma_f32_32x32x16_bf16 v[48:63], v[140:143], v[80:83], v[48:63]
    v_mfma_f32_32x32x16_bf16 v[64:79], v[140:143], v[84:87], v[64:79]
    s_add_u32 m0, s66, 10240
    s_add_u32 s68, s58, 7168
    buffer_load_dwordx4 v3, s[40:43], s58 offen lds
    s_add_u32 m0, s66, 11264
    s_add_u32 s58, s58, 14336
    buffer_load_dwordx4 v3, s[40:43], s68 offen lds
    buffer_load_dwordx4 v[120:123], v2, s[44:47], s59 offen offset:1024 sc1
    buffer_load_dwordx4 v[124:127], v2, s[44:47], s60 offen offset:1024 sc1
    s_waitcnt vmcnt(12)
    ds_read_b64_tr_b16 v[136:137], v4 offset:4096
    ds_read_b64_tr_b16 v[138:139], v4 offset:5120
    ds_read_b64_tr_b16 v[140:141], v5 offset:4096
    ds_read_b64_tr_b16 v[142:143], v5 offset:5120
    s_waitcnt lgkmcnt(4)
    v_mfma_f32_32x32x16_bf16 v[16:31], v[144:147], v[88:91], v[16:31]
    v_mfma_f32_32x32x16_bf16 v[32:47], v[144:147], v[92:95], v[32:47]
    v_mfma_f32_32x32x16_bf16 v[48:63], v[148:151], v[88:91], v[48:63]
    v_mfma_f32_32x32x16_bf16 v[64:79], v[148:151], v[92:95], v[64:79]
    s_add_u32 m0, s66, 0
    s_add_u32 s68, s58, 7168
    buffer_load_dwordx4 v3, s[40:43], s58 offen lds
    s_add_u32 m0, s66, 1024
    s_add_u32 s58, s58, 14336
    buffer_load_dwordx4 v3, s[40:43], s68 offen lds
    buffer_load_dwordx4 v[80:83], v2, s[44:47], s59 offen offset:2048 sc1
    buffer_load_dwordx4 v[84:87], v2, s[44:47], s60 offen offset:2048 sc1
    s_waitcnt vmcnt(12)
    ds_read_b64_tr_b16 v[144:145], v4 offset:6144
    ds_read_b64_tr_b16 v[146:147], v4 offset:7168
    ds_read_b64_tr_b16 v[148:149], v5 offset:6144
    ds_read_b64_tr_b16 v[150:151], v5 offset:7168
    s_waitcnt lgkmcnt(4)
    v_mfma_f32_32x32x16_bf16 v[16:31], v[136:139], v[96:99], v[16:31]
    v_mfma_f32_32x32x16_bf16 v[32:47], v[136:139], v[100:103], v[32:47]
    v_mfma_f32_32x32x16_bf16 v[48:63], v[140:143], v[96:99], v[48:63]
    v_mfma_f32_32x32x16_bf16 v[64:79], v[140:143], v[100:103], v[64:79]
    s_add_u32 m0, s66, 2048
    s_add_u32 s68, s58, 7168
    buffer_load_dwordx4 v3, s[40:43], s58 offen lds
    s_add_u32 m0, s66, 3072
    s_add_u32 s58, s58, 14336
    buffer_load_dwordx4 v3, s[40:43], s68 offen lds
    buffer_load_dwordx4 v[88:91], v2, s[44:47], s59 offen offset:3072 sc1
    buffer_load_dwordx4 v[92:95], v2, s[44:47], s60 offen offset:3072 sc1
    s_add_u32 s59, s59, 4096
    s_add_u32 s60, s60, 4096
    s_waitcnt vmcnt(12)
    ds_read_b64_tr_b16 v[136:137], v4 offset:8192
    ds_read_b64_tr_b16 v[138:139], v4 offset:9216
    ds_read_b64_tr_b16 v[140:141], v5 offset:8192
    ds_read_b64_tr_b16 v[142:143], v5 offset:9216
    s_waitcnt lgkmcnt(4)
    v_mfma_f32_32x32x16_bf16 v[16:31], v[144:147], v[104:107], v[16:31]
    v_mfma_f32_32x32x16_bf16 v[32:47], v[144:147], v[108:111], v[32:47]
    v_mfma_f32_32x32x16_bf16 v[48:63], v[148:151], v[104:107], v[48:63]
    v_mfma_f32_32x32x16_bf16 v[64:79], v[148:151], v[108:111], v[64:79]
    s_add_u32 m0, s66, 4096
    s_add_u32 s68, s58, 7168
    buffer_load_dwordx4 v3, s[40:43], s58 offen lds
    s_add_u32 m0, s66, 5120
    s_add_u32 s58, s58, 14336
    buffer_load_dwordx4 v3, s[40:43], s68 offen lds
    buffer_load_dwordx4 v[96:99], v2, s[44:47], s59 offen offset:0 sc1
    buffer_load_dwordx4 v[100:103], v2, s[44:47], s60 offen offset:0 sc1
    s_waitcnt vmcnt(12)
    ds_read_b64_tr_b16 v[144:145], v4 offset:10240
    ds_read_b64_tr_b16 v[146:147], v4 offset:11264
    ds_read_b64_tr_b16 v[148:149], v5 offset:10240
    ds_read_b64_tr_b16 v[150:151], v5 offset:11264
    s_waitcnt lgkmcnt(4)
    v_mfma_f32_32x32x16_bf16 v[16:31], v[136:139], v[112:115], v[16:31]
    v_mfma_f32_32x32x16_bf16 v[32:47], v[136:139], v[116:119], v[32:47]
    v_mfma_f32_32x32x16_bf16 v[48:63], v[140:143], v[112:115], v[48:63]
    v_mfma_f32_32x32x16_bf16 v[64:79], v[140:143], v[116:119], v[64:79]
    s_add_u32 m0, s66, 6144
    s_add_u32 s68, s58, 7168
    buffer_load_dwordx4 v3, s[40:43], s58 offen lds
    s_add_u32 m0, s66, 7168
    s_add_u32 s58, s58, 14336
    buffer_load_dwordx4 v3, s[40:43], s68 offen lds
    buffer_load_dwordx4 v[104:107], v2, s[44:47], s59 offen offset:1024 sc1
    buffer_load_dwordx4 v[108:111], v2, s[44:47], s60 offen offset:1024 sc1
    s_waitcnt vmcnt(12)
    ds_read_b64_tr_b16 v[136:137], v4 offset:0
    ds_read_b64_tr_b16 v[138:139], v4 offset:1024
    ds_read_b64_tr_b16 v[140:141], v5 offset:0
    ds_read_b64_tr_b16 v[142:143], v5 offset:1024
    s_waitcnt lgkmcnt(4)
    v_mfma_f32_32x32x16_bf16 v[16:31], v[144:147], v[120:123], v[16:31]
    v_mfma_f32_32x32x16_bf16 v[32:47], v[144:147], v[124:127], v[32:47]
    v_mfma_f32_32x32x16_bf16 v[48:63], v[148:151], v[120:123], v[48:63]
    v_mfma_f32_32x32x16_bf16 v[64:79], v[148:151], v[124:127], v[64:79]
    s_add_u32 m0, s66, 8192
    s_add_u32 s68, s58, 7168
    buffer_load_dwordx4 v3, s[40:43], s58 offen lds
    s_add_u32 m0, s66, 9216
    s_add_u32 s58, s58, 14336
    buffer_load_dwordx4 v3, s[40:43], s68 offen lds
    buffer_load_dwordx4 v[112:115], v2, s[44:47], s59 offen offset:2048 sc1
    buffer_load_dwordx4 v[116:119], v2, s[44:47], s60 offen offset:2048 sc1
    s_waitcnt vmcnt(12)
    ds_read_b64_tr_b16 v[144:145], v4 offset:2048
    ds_read_b64_tr_b16 v[146:147], v4 offset:3072
    ds_read_b64_tr_b16 v[148:149], v5 offset:2048
    ds_read_b64_tr_b16 v[150:151], v5 offset:3072
    s_waitcnt lgkmcnt(4)
    v_mfma_f32_32x32x16_bf16 v[16:31], v[136:139], v[80:83], v[16:31]
    v_mfma_f32_32x32x16_bf16 v[32:47], v[136:139], v[84:87], v[32:47]
    v_mfma_f32_32x32x16_bf16 v[48:63], v[140:143], v[80:83], v[48:63]
    v_mfma_f32_32x32x16_bf16 v[64:79], v[140:143], v[84:87], v[64:79]
    s_add_u32 m0, s66, 10240
    s_add_u32 s68, s58, 7168
    buffer_load_dwordx4 v3, s[40:43], s58 offen lds
    s_add_u32 m0, s66, 11264
    s_add_u32 s58, s58, 14336
    buffer_load_dwordx4 v3, s[40:43], s68 offen lds
    buffer_load_dwordx4 v[120:123], v2, s[44:47], s59 offen offset:3072 sc1
    buffer_load_dwordx4 v[124:127], v2, s[44:47], s60 offen offset:3072 sc1
    s_add_u32 s59, s59, 4096
    s_add_u32 s60, s60, 4096
    s_waitcnt vmcnt(12)
    ds_read_b64_tr_b16 v[136:137], v4 offset:4096
    ds_read_b64_tr_b16 v[138:139], v4 offset:5120
    ds_read_b64_tr_b16 v[140:141], v5 offset:4096
    ds_read_b64_tr_b16 v[142:143], v5 offset:5120
    s_waitcnt lgkmcnt(4)
    v_mfma_f32_32x32x16_bf16 v[16:31], v[144:147], v[88:91], v[16:31]
    v_mfma_f32_32x32x16_bf16 v[32:47], v[144:147], v[92:95], v[32:47]
    v_mfma_f32_32x32x16_bf16 v[48:63], v[148:151], v[88:91], v[48:63]
    v_mfma_f32_32x32x16_bf16 v[64:79], v[148:151], v[92:95], v[64:79]
    s_add_u32 m0, s66, 0
    s_add_u32 s68, s58, 7168
    buffer_load_dwordx4 v3, s[40:43], s58 offen lds
    s_add_u32 m0, s66, 1024
    s_add_u32 s58, s58, 14336
    buffer_load_dwordx4 v3, s[40:43], s68 offen lds
    buffer_load_dwordx4 v[80:83], v2, s[44:47], s59 offen offset:0 sc1
    buffer_load_dwordx4 v[84:87], v2, s[44:47], s60 offen offset:0 sc1
    s_waitcnt vmcnt(12)
    ds_read_b64_tr_b16 v[144:145], v4 offset:6144
    ds_read_b64_tr_b16 v[146:147], v4 offset:7168
    ds_read_b64_tr_b16 v[148:149], v5 offset:6144
    ds_read_b64_tr_b16 v[150:151], v5 offset:7168
    s_waitcnt lgkmcnt(4)
    v_mfma_f32_32x32x16_bf16 v[16:31], v[136:139], v[96:99], v[16:31]
    v_mfma_f32_32x32x16_bf16 v[32:47], v[136:139], v[100:103], v[32:47]
    v_mfma_f32_32x32x16_bf16 v[48:63], v[140:143], v[96:99], v[48:63]
    v_mfma_f32_32x32x16_bf16 v[64:79], v[140:143], v[100:103], v[64:79]
    s_add_u32 m0, s66, 2048
    s_add_u32 s68, s58, 7168
    buffer_load_dwordx4 v3, s[40:43], s58 offen lds
    s_add_u32 m0, s66, 3072
    s_add_u32 s58, s58, 14336
    buffer_load_dwordx4 v3, s[40:43], s68 offen lds
    buffer_load_dwordx4 v[88:91], v2, s[44:47], s59 offen offset:1024 sc1
    buffer_load_dwordx4 v[92:95], v2, s[44:47], s60 offen offset:1024 sc1
    s_waitcnt vmcnt(12)
    ds_read_b64_tr_b16 v[136:137], v4 offset:8192
    ds_read_b64_tr_b16 v[138:139], v4 offset:9216
    ds_read_b64_tr_b16 v[140:141], v5 offset:8192
    ds_read_b64_tr_b16 v[142:143], v5 offset:9216
    s_waitcnt lgkmcnt(4)
    v_mfma_f32_32x32x16_bf16 v[16:31], v[144:147], v[104:107], v[16:31]
    v_mfma_f32_32x32x16_bf16 v[32:47], v[144:147], v[108:111], v[32:47]
    v_mfma_f32_32x32x16_bf16 v[48:63], v[148:151], v[104:107], v[48:63]
    v_mfma_f32_32x32x16_bf16 v[64:79], v[148:151], v[108:111], v[64:79]
    s_add_u32 m0, s66, 4096
    s_add_u32 s68, s58, 7168
    buffer_load_dwordx4 v3, s[40:43], s58 offen lds
    s_add_u32 m0, s66, 5120
    s_add_u32 s58, s58, 14336
    buffer_load_dwordx4 v3, s[40:43], s68 offen lds
    buffer_load_dwordx4 v[96:99], v2, s[44:47], s59 offen offset:2048 sc1
    buffer_load_dwordx4 v[100:103], v2, s[44:47], s60 offen offset:2048 sc1
    s_waitcnt vmcnt(12)
    ds_read_b64_tr_b16 v[144:145], v4 offset:10240
    ds_read_b64_tr_b16 v[146:147], v4 offset:11264
    ds_read_b64_tr_b16 v[148:149], v5 offset:10240
    ds_read_b64_tr_b16 v[150:151], v5 offset:11264
    s_waitcnt lgkmcnt(4)
    v_mfma_f32_32x32x16_bf16 v[16:31], v[136:139], v[112:115], v[16:31]
    v_mfma_f32_32x32x16_bf16 v[32:47], v[136:139], v[116:119], v[32:47]
    v_mfma_f32_32x32x16_bf16 v[48:63], v[140:143], v[112:115], v[48:63]
    v_mfma_f32_32x32x16_bf16 v[64:79], v[140:143], v[116:119], v[64:79]
    s_add_u32 m0, s66, 6144
    s_add_u32 s68, s58, 7168
    buffer_load_dwordx4 v3, s[40:43], s58 offen lds
    s_add_u32 m0, s66, 7168
    s_add_u32 s58, s58, 14336
    buffer_load_dwordx4 v3, s[40:43], s68 offen lds
    buffer_load_dwordx4 v[104:107], v2, s[44:47], s59 offen offset:3072 sc1
    buffer_load_dwordx4 v[108:111], v2, s[44:47], s60 offen offset:3072 sc1
    s_add_u32 s59, s59, 4096
    s_add_u32 s60, s60, 4096
    s_waitcnt vmcnt(12)
    ds_read_b64_tr_b16 v[136:137], v4 offset:0
    ds_read_b64_tr_b16 v[138:139], v4 offset:1024
    ds_read_b64_tr_b16 v[140:141], v5 offset:0
    ds_read_b64_tr_b16 v[142:143], v5 offset:1024
    s_waitcnt lgkmcnt(4)
    v_mfma_f32_32x32x16_bf16 v[16:31], v[144:147], v[120:123], v[16:31]
    v_mfma_f32_32x32x16_bf16 v[32:47], v[144:147], v[124:127], v[32:47]
    v_mfma_f32_32x32x16_bf16 v[48:63], v[148:151], v[120:123], v[48:63]
    v_mfma_f32_32x32x16_bf16 v[64:79], v[148:151], v[124:127], v[64:79]
    s_mul_i32 s59, s62, 15360
    s_mul_i32 s58, s62, 100352
    s_add_u32 s58, s58, s64
    s_add_u32 m0, s59, 98304
    s_nop 0
    buffer_load_dwordx4 v3, s[36:39], s58 offen lds
    s_add_u32 m0, s59, 99328
    s_add_u32 s58, s58, 7168
    buffer_load_dwordx4 v3, s[36:39], s58 offen lds
    s_add_u32 m0, s59, 100352
    s_add_u32 s58, s58, 7168
    buffer_load_dwordx4 v3, s[36:39], s58 offen lds
    s_add_u32 m0, s59, 101376
    s_add_u32 s58, s58, 7168
    buffer_load_dwordx4 v3, s[36:39], s58 offen lds
    s_waitcnt vmcnt(12)
    ds_read_b64_tr_b16 v[144:145], v4 offset:2048
    ds_read_b64_tr_b16 v[146:147], v4 offset:3072
    ds_read_b64_tr_b16 v[148:149], v5 offset:2048
    ds_read_b64_tr_b16 v[150:151], v5 offset:3072
    s_waitcnt lgkmcnt(4)
    v_mfma_f32_32x32x16_bf16 v[16:31], v[136:139], v[80:83], v[16:31]
    v_mfma_f32_32x32x16_bf16 v[32:47], v[136:139], v[84:87], v[32:47]
    v_mfma_f32_32x32x16_bf16 v[48:63], v[140:143], v[80:83], v[48:63]
    v_mfma_f32_32x32x16_bf16 v[64:79], v[140:143], v[84:87], v[64:79]
    s_add_u32 m0, s59, 102400
    s_add_u32 s58, s58, 7168
    buffer_load_dwordx4 v3, s[36:39], s58 offen lds
    s_add_u32 m0, s59, 103424
    s_add_u32 s58, s58, 7168
    buffer_load_dwordx4 v3, s[36:39], s58 offen lds
    s_add_u32 m0, s59, 104448
    s_add_u32 s58, s58, 7168
    buffer_load_dwordx4 v3, s[36:39], s58 offen lds
    s_add_u32 m0, s59, 105472
    s_add_u32 s58, s58, 7168
    buffer_load_dwordx4 v3, s[36:39], s58 offen lds
    s_waitcnt vmcnt(12)
    ds_read_b64_tr_b16 v[136:137], v4 offset:4096
    ds_read_b64_tr_b16 v[138:139], v4 offset:5120
    ds_read_b64_tr_b16 v[140:141], v5 offset:4096
    ds_read_b64_tr_b16 v[142:143], v5 offset:5120
    s_waitcnt lgkmcnt(4)
    v_mfma_f32_32x32x16_bf16 v[16:31], v[144:147], v[88:91], v[16:31]
    v_mfma_f32_32x32x16_bf16 v[32:47], v[144:147], v[92:95], v[32:47]
    v_mfma_f32_32x32x16_bf16 v[48:63], v[148:151], v[88:91], v[48:63]
    v_mfma_f32_32x32x16_bf16 v[64:79], v[148:151], v[92:95], v[64:79]
    s_add_u32 m0, s59, 106496
    s_add_u32 s58, s58, 7168
    buffer_load_dwordx4 v3, s[36:39], s58 offen lds
    s_add_u32 m0, s59, 107520
    s_add_u32 s58, s58, 7168
    buffer_load_dwordx4 v3, s[36:39], s58 offen lds
    s_add_u32 m0, s59, 108544
    s_add_u32 s58, s58, 7168
    buffer_load_dwordx4 v3, s[36:39], s58 offen lds
    s_add_u32 m0, s59, 109568
    s_add_u32 s58, s58, 7168
    buffer_load_dwordx4 v3, s[36:39], s58 offen lds
    s_waitcnt vmcnt(12)
    ds_read_b64_tr_b16 v[144:145], v4 offset:6144
    ds_read_b64_tr_b16 v[146:147], v4 offset:7168
    ds_read_b64_tr_b16 v[148:149], v5 offset:6144
    ds_read_b64_tr_b16 v[150:151], v5 offset:7168
    s_waitcnt lgkmcnt(4)
    v_mfma_f32_32x32x16_bf16 v[16:31], v[136:139], v[96:99], v[16:31]
    v_mfma_f32_32x32x16_bf16 v[32:47], v[136:139], v[100:103], v[32:47]
    v_mfma_f32_32x32x16_bf16 v[48:63], v[140:143], v[96:99], v[48:63]
    v_mfma_f32_32x32x16_bf16 v[64:79], v[140:143], v[100:103], v[64:79]
    s_add_u32 m0, s59, 110592
    s_add_u32 s58, s58, 7168
    buffer_load_dwordx4 v3, s[36:39], s58 offen lds
    s_add_u32 m0, s59, 111616
    s_add_u32 s58, s58, 7168
    buffer_load_dwordx4 v3, s[36:39], s58 offen lds
    s_add_u32 m0, s59, 112640
    s_add_u32 s58, s58, 7168
    buffer_load_dwordx4 v3, s[36:39], s58 offen lds
    buffer_load_dwordx2 v[232:233], v6, s[24:27], s61 offen offset:0
    s_waitcnt lgkmcnt(0)
    v_mfma_f32_32x32x16_bf16 v[16:31], v[144:147], v[104:107], v[16:31]
    v_mfma_f32_32x32x16_bf16 v[32:47], v[144:147], v[108:111], v[32:47]
    v_mfma_f32_32x32x16_bf16 v[48:63], v[148:151], v[104:107], v[48:63]
    v_mfma_f32_32x32x16_bf16 v[64:79], v[148:151], v[108:111], v[64:79]
    buffer_load_dwordx2 v[234:235], v6, s[24:27], s61 offen offset:16
    buffer_load_dwordx2 v[236:237], v6, s[24:27], s61 offen offset:32
    buffer_load_dwordx2 v[238:239], v6, s[24:27], s61 offen offset:48
    s_setprio 0
    s_and_b32 s68, s62, 2
    s_mul_i32 s70, s68, 15360
    s_add_u32 s70, s70, 98304
    s_sub_u32 s70, s70, s66
    v_add_u32 v4, s70, v4
    v_add_u32 v5, s70, v5
    s_and_b32 s69, s62, 1
    s_lshl1_add_u32 s69, s63, s69
    s_lshl2_add_u32 s69, s69, s68
    s_lshl_b32 s59, s69, 13
    s_add_u32 s59, s59, 13631488
    v_min_u32 v8, 1, v1
    s_add_u32 s69, s69, 28
    v_add_lshl_u32 v7, v8, s69, 7
    s_mov_b32 s32, s18
    s_mov_b32 s33, s19
    s_mov_b32 s34, 0x1c0000
    s_mov_b32 s35, 0x20000
    s_waitcnt vmcnt(0)
    s_mov_b32 s70, 18350080
    buffer_load_dword v9, v7, s[44:47], s70 offen sc1
    v_add_u32 v152, s66, v2
    ds_write_b128 v152, v[32:35] offset:0
    ds_write_b128 v152, v[36:39] offset:1024
    ds_write_b128 v152, v[40:43] offset:2048
    ds_write_b128 v152, v[44:47] offset:3072
    s_xor_b32 s68, s62, 1
    s_mul_i32 s68, s68, 12288
    v_add_u32 v155, s68, v2
    ds_write_b128 v152, v[48:51] offset:4096
    ds_write_b128 v152, v[52:55] offset:5120
    ds_write_b128 v152, v[56:59] offset:6144
    ds_write_b128 v152, v[60:63] offset:7168
    s_xor_b32 s68, s62, 2
    s_mul_i32 s68, s68, 12288
    v_add_u32 v156, s68, v2
    ds_write_b128 v152, v[64:67] offset:8192
    ds_write_b128 v152, v[68:71] offset:9216
    ds_write_b128 v152, v[72:75] offset:10240
    ds_write_b128 v152, v[76:79] offset:11264
    s_xor_b32 s68, s62, 3
    s_mul_i32 s68, s68, 12288
    v_add_u32 v157, s68, v2
    s_waitcnt lgkmcnt(0)
    v_mov_b32 v153, 163600
    v_mov_b32 v154, 1
    s_mov_b64 exec, 1
    ds_add_u32 v153, v154
    s_mov_b64 exec, -1
    s_mov_b32 s69, 0x400000
L_ls104:
    ds_read_b32 v154, v153
    s_waitcnt lgkmcnt(0)
    v_readfirstlane_b32 s68, v154
    s_sub_u32 s69, s69, 1
    s_cselect_b32 s68, 4, s68
    s_cmp_lt_u32 s68, 4
    s_cbranch_scc1 L_ls104
    ds_read_b128 v[32:35], v155 offset:0
    ds_read_b128 v[36:39], v155 offset:1024
    ds_read_b128 v[40:43], v155 offset:2048
    ds_read_b128 v[44:47], v155 offset:3072
    ds_read_b128 v[48:51], v156 offset:4096
    ds_read_b128 v[52:55], v156 offset:5120
    ds_read_b128 v[56:59], v156 offset:6144
    ds_read_b128 v[60:63], v156 offset:7168
    ds_read_b128 v[64:67], v157 offset:8192
    ds_read_b128 v[68:71], v157 offset:9216
    ds_read_b128 v[72:75], v157 offset:10240
    ds_read_b128 v[76:79], v157 offset:11264
    s_waitcnt lgkmcnt(8)
    v_add_f32 v16, v16, v32
    v_add_f32 v17, v17, v33
    v_add_f32 v18, v18, v34
    v_add_f32 v19, v19, v35
    v_add_f32 v20, v20, v36
    v_add_f32 v21, v21, v37
    v_add_f32 v22, v22, v38
    v_add_f32 v23, v23, v39
    v_add_f32 v24, v24, v40
    v_add_f32 v25, v25, v41
    v_add_f32 v26, v26, v42
    v_add_f32 v27, v27, v43
    v_add_f32 v28, v28, v44
    v_add_f32 v29, v29, v45
    v_add_f32 v30, v30, v46
    v_add_f32 v31, v31, v47
    s_waitcnt lgkmcnt(4)
    v_add_f32 v16, v16, v48
    v_add_f32 v17, v17, v49
    v_add_f32 v18, v18, v50
    v_add_f32 v19, v19, v51
    v_add_f32 v20, v20, v52
    v_add_f32 v21, v21, v53
    v_add_f32 v22, v22, v54
    v_add_f32 v23, v23, v55
    v_add_f32 v24, v24, v56
    v_add_f32 v25, v25, v57
    v_add_f32 v26, v26, v58
    v_add_f32 v27, v27, v59
    v_add_f32 v28, v28, v60
    v_add_f32 v29, v29, v61
    v_add_f32 v30, v30, v62
    v_add_f32 v31, v31, v63
    s_waitcnt lgkmcnt(0)
    v_add_f32 v16, v16, v64
    v_add_f32 v17, v17, v65
    v_add_f32 v18, v18, v66
    v_add_f32 v19, v19, v67
    v_add_f32 v20, v20, v68
    v_add_f32 v21, v21, v69
    v_add_f32 v22, v22, v70
    v_add_f32 v23, v23, v71
    v_add_f32 v24, v24, v72
    v_add_f32 v25, v25, v73
    v_add_f32 v26, v26, v74
    v_add_f32 v27, v27, v75
    v_add_f32 v28, v28, v76
    v_add_f32 v29, v29, v77
    v_add_f32 v30, v30, v78
    v_add_f32 v31, v31, v79
    v_mov_b32 v153, 163604
    v_mov_b32 v154, 1
    s_mov_b64 exec, 1
    ds_add_u32 v153, v154
    s_mov_b64 exec, -1
    ds_read_b64_tr_b16 v[160:161], v4 offset:0
    ds_read_b64_tr_b16 v[162:163], v4 offset:1024
    ds_read_b64_tr_b16 v[164:165], v5 offset:0
    ds_read_b64_tr_b16 v[166:167], v5 offset:1024
    ds_read_b64_tr_b16 v[168:169], v4 offset:2048
    ds_read_b64_tr_b16 v[170:171], v4 offset:3072
    ds_read_b64_tr_b16 v[172:173], v5 offset:2048
    ds_read_b64_tr_b16 v[174:175], v5 offset:3072
    ds_read_b64_tr_b16 v[176:177], v4 offset:3584
    ds_read_b64_tr_b16 v[178:179], v4 offset:4608
    ds_read_b64_tr_b16 v[180:181], v5 offset:3584
    ds_read_b64_tr_b16 v[182:183], v5 offset:4608
    ds_read_b64_tr_b16 v[184:185], v4 offset:5632
    ds_read_b64_tr_b16 v[186:187], v4 offset:6656
    ds_read_b64_tr_b16 v[188:189], v5 offset:5632
    ds_read_b64_tr_b16 v[190:191], v5 offset:6656
    ds_read_b64_tr_b16 v[192:193], v4 offset:7168
    ds_read_b64_tr_b16 v[194:195], v4 offset:8192
    ds_read_b64_tr_b16 v[196:197], v5 offset:7168
    ds_read_b64_tr_b16 v[198:199], v5 offset:8192
    ds_read_b64_tr_b16 v[200:201], v4 offset:9216
    ds_read_b64_tr_b16 v[202:203], v4 offset:10240
    ds_read_b64_tr_b16 v[204:205], v5 offset:9216
    ds_read_b64_tr_b16 v[206:207], v5 offset:10240
    ds_read_b64_tr_b16 v[208:209], v4 offset:10752
    ds_read_b64_tr_b16 v[210:211], v4 offset:11776
    ds_read_b64_tr_b16 v[212:213], v5 offset:10752
    ds_read_b64_tr_b16 v[214:215], v5 offset:11776
    ds_read_b64_tr_b16 v[216:217], v4 offset:12800
    ds_read_b64_tr_b16 v[218:219], v4 offset:13824
    ds_read_b64_tr_b16 v[220:221], v5 offset:12800
    ds_read_b64_tr_b16 v[222:223], v5 offset:13824
    ds_read_b64_tr_b16 v[48:49], v4 offset:15360
    ds_read_b64_tr_b16 v[50:51], v4 offset:16384
    ds_read_b64_tr_b16 v[52:53], v5 offset:15360
    ds_read_b64_tr_b16 v[54:55], v5 offset:16384
    ds_read_b64_tr_b16 v[56:57], v4 offset:17408
    ds_read_b64_tr_b16 v[58:59], v4 offset:18432
    ds_read_b64_tr_b16 v[60:61], v5 offset:17408
    ds_read_b64_tr_b16 v[62:63], v5 offset:18432
    ds_read_b64_tr_b16 v[64:65], v4 offset:18944
    ds_read_b64_tr_b16 v[66:67], v4 offset:19968
    ds_read_b64_tr_b16 v[68:69], v5 offset:18944
    ds_read_b64_tr_b16 v[70:71], v5 offset:19968
    ds_read_b64_tr_b16 v[72:73], v4 offset:20992
    ds_read_b64_tr_b16 v[74:75], v4 offset:22016
    ds_read_b64_tr_b16 v[76:77], v5 offset:20992
    ds_read_b64_tr_b16 v[78:79], v5 offset:22016
    v_mul_f32 v32, 0xbfb8aa3b, v16
    v_mul_f32 v33, 0xbfb8aa3b, v17
    v_mul_f32 v34, 0xbfb8aa3b, v18
    v_mul_f32 v35, 0xbfb8aa3b, v19
    v_mul_f32 v36, 0xbfb8aa3b, v20
    v_mul_f32 v37, 0xbfb8aa3b, v21
    v_mul_f32 v38, 0xbfb8aa3b, v22
    v_mul_f32 v39, 0xbfb8aa3b, v23
    v_mul_f32 v40, 0xbfb8aa3b, v24
    v_mul_f32 v41, 0xbfb8aa3b, v25
    v_mul_f32 v42, 0xbfb8aa3b, v26
    v_mul_f32 v43, 0xbfb8aa3b, v27
    v_mul_f32 v44, 0xbfb8aa3b, v28
    v_mul_f32 v45, 0xbfb8aa3b, v29
    v_mul_f32 v46, 0xbfb8aa3b, v30
    v_mul_f32 v47, 0xbfb8aa3b, v31
    v_exp_f32 v32, v32
    v_exp_f32 v33, v33
    v_exp_f32 v34, v34
    v_exp_f32 v35, v35
    v_exp_f32 v36, v36
    v_exp_f32 v37, v37
    v_exp_f32 v38, v38
    v_exp_f32 v39, v39
    v_exp_f32 v40, v40
    v_exp_f32 v41, v41
    v_exp_f32 v42, v42
    v_exp_f32 v43, v43
    v_exp_f32 v44, v44
    v_exp_f32 v45, v45
    v_exp_f32 v46, v46
    v_exp_f32 v47, v47
    v_add_f32 v32, 1.0, v32
    v_add_f32 v33, 1.0, v33
    v_add_f32 v34, 1.0, v34
    v_add_f32 v35, 1.0, v35
    v_add_f32 v36, 1.0, v36
    v_add_f32 v37, 1.0, v37
    v_add_f32 v38, 1.0, v38
    v_add_f32 v39, 1.0, v39
    v_add_f32 v40, 1.0, v40
    v_add_f32 v41, 1.0, v41
    v_add_f32 v42, 1.0, v42
    v_add_f32 v43, 1.0, v43
    v_add_f32 v44, 1.0, v44
    v_add_f32 v45, 1.0, v45
    v_add_f32 v46, 1.0, v46
    v_add_f32 v47, 1.0, v47
    v_rcp_f32 v32, v32
    v_rcp_f32 v33, v33
    v_rcp_f32 v34, v34
    v_rcp_f32 v35, v35
    v_rcp_f32 v36, v36
    v_rcp_f32 v37, v37
    v_rcp_f32 v38, v38
    v_rcp_f32 v39, v39
    v_rcp_f32 v40, v40
    v_rcp_f32 v41, v41
    v_rcp_f32 v42, v42
    v_rcp_f32 v43, v43
    v_rcp_f32 v44, v44
    v_rcp_f32 v45, v45
    v_rcp_f32 v46, v46
    v_rcp_f32 v47, v47
    v_mul_f32 v240, v16, v32
    v_mul_f32 v241, v17, v33
    v_mul_f32 v242, v18, v34
    v_mul_f32 v243, v19, v35
    v_mul_f32 v244, v20, v36
    v_mul_f32 v245, v21, v37
    v_mul_f32 v246, v22, v38
    v_mul_f32 v247, v23, v39
    v_mul_f32 v248, v24, v40
    v_mul_f32 v249, v25, v41
    v_mul_f32 v250, v26, v42
    v_mul_f32 v251, v27, v43
    v_mul_f32 v252, v28, v44
    v_mul_f32 v253, v29, v45
    v_mul_f32 v254, v30, v46
    v_mul_f32 v255, v31, v47
    v_lshlrev_b32 v224, 16, v232
    v_and_b32 v225, 0xffff0000, v232
    v_lshlrev_b32 v226, 16, v233
    v_and_b32 v227, 0xffff0000, v233
    v_lshlrev_b32 v228, 16, v234
    v_and_b32 v229, 0xffff0000, v234
    v_lshlrev_b32 v230, 16, v235
    v_and_b32 v231, 0xffff0000, v235
    v_lshlrev_b32 v232, 16, v236
    v_and_b32 v233, 0xffff0000, v236
    v_lshlrev_b32 v234, 16, v237
    v_and_b32 v235, 0xffff0000, v237
    v_lshlrev_b32 v236, 16, v238
    v_and_b32 v237, 0xffff0000, v238
    v_lshlrev_b32 v238, 16, v239
    v_and_b32 v239, 0xffff0000, v239
    v_lshrrev_b32 v8, 5, v1
    v_lshl_add_u32 v6, v8, 3, v6
    s_xor_b32 s68, s62, 2
    s_mul_i32 s68, s68, 12288
    v_add_u32 v12, s66, v2
    v_add_u32 v13, s68, v2
    s_and_b32 s68, s62, 1
    s_lshl2_add_u32 s68, s68, 163648
    v_mov_b32 v14, s68
    s_waitcnt vmcnt(0)
    s_setprio 2
    v_cmp_gt_u32 s[74:75], 4, v9
    s_nop 0
    s_cmp_eq_u64 s[74:75], 0
    s_cbranch_scc1 L_oe
    s_mov_b32 s69, 0x40000
    s_mov_b32 s70, 18350080
L_po105:
    buffer_load_dword v9, v7, s[44:47], s70 offen sc1
    s_waitcnt vmcnt(0)
    v_cmp_gt_u32 s[74:75], 4, v9
    s_nop 0
    s_cmp_eq_u64 s[74:75], 0
    s_cbranch_scc1 L_pd106
    s_sleep 1
    s_sub_u32 s69, s69, 1
    s_cbranch_scc0 L_po105
L_pd106:
L_oe:
    buffer_load_dwordx4 v[80:83], v2, s[44:47], s59 offen offset:0 sc1
    buffer_load_dwordx4 v[84:87], v2, s[44:47], s59 offen offset:1024 sc1
    buffer_load_dwordx4 v[88:91], v2, s[44:47], s59 offen offset:2048 sc1
    buffer_load_dwordx4 v[92:95], v2, s[44:47], s59 offen offset:3072 sc1
    s_add_u32 s59, s59, 4096
    buffer_load_dwordx4 v[96:99], v2, s[44:47], s59 offen offset:0 sc1
    buffer_load_dwordx4 v[100:103], v2, s[44:47], s59 offen offset:1024 sc1
    buffer_load_dwordx4 v[104:107], v2, s[44:47], s59 offen offset:2048 sc1
    buffer_load_dwordx4 v[108:111], v2, s[44:47], s59 offen offset:3072 sc1
    s_add_u32 s59, s59, 4096
    buffer_load_dwordx4 v[112:115], v2, s[44:47], s59 offen offset:0 sc1
    buffer_load_dwordx4 v[116:119], v2, s[44:47], s59 offen offset:1024 sc1
    buffer_load_dwordx4 v[120:123], v2, s[44:47], s59 offen offset:2048 sc1
    buffer_load_dwordx4 v[124:127], v2, s[44:47], s59 offen offset:3072 sc1
    s_add_u32 s59, s59, 4096
    buffer_load_dwordx4 v[128:131], v2, s[44:47], s59 offen offset:0 sc1
    buffer_load_dwordx4 v[132:135], v2, s[44:47], s59 offen offset:1024 sc1
    buffer_load_dwordx4 v[136:139], v2, s[44:47], s59 offen offset:2048 sc1
    buffer_load_dwordx4 v[140:143], v2, s[44:47], s59 offen offset:3072 sc1
    s_waitcnt lgkmcnt(0)
    v_mov_b32 v10, 163604
    ds_read_b32 v11, v10
    s_waitcnt vmcnt(15)
    v_mfma_f32_32x32x16_bf16 v[32:47], v[164:167], v[80:83], 0
    v_mfma_f32_32x32x16_bf16 v[16:31], v[160:163], v[80:83], 0
    s_waitcnt vmcnt(14)
    v_mfma_f32_32x32x16_bf16 v[32:47], v[172:175], v[84:87], v[32:47]
    v_mfma_f32_32x32x16_bf16 v[16:31], v[168:171], v[84:87], v[16:31]
    ds_read_b64_tr_b16 v[160:161], v4 offset:22528
    ds_read_b64_tr_b16 v[162:163], v4 offset:23552
    ds_read_b64_tr_b16 v[164:165], v5 offset:22528
    ds_read_b64_tr_b16 v[166:167], v5 offset:23552
    s_waitcnt vmcnt(13)
    v_mfma_f32_32x32x16_bf16 v[32:47], v[180:183], v[88:91], v[32:47]
    v_mfma_f32_32x32x16_bf16 v[16:31], v[176:179], v[88:91], v[16:31]
    ds_read_b64_tr_b16 v[168:169], v4 offset:24576
    ds_read_b64_tr_b16 v[170:171], v4 offset:25600
    ds_read_b64_tr_b16 v[172:173], v5 offset:24576
    ds_read_b64_tr_b16 v[174:175], v5 offset:25600
    s_waitcnt vmcnt(12)
    v_mfma_f32_32x32x16_bf16 v[32:47], v[188:191], v[92:95], v[32:47]
    v_mfma_f32_32x32x16_bf16 v[16:31], v[184:187], v[92:95], v[16:31]
    ds_read_b64_tr_b16 v[176:177], v4 offset:26112
    ds_read_b64_tr_b16 v[178:179], v4 offset:27136
    ds_read_b64_tr_b16 v[180:181], v5 offset:26112
    ds_read_b64_tr_b16 v[182:183], v5 offset:27136
    s_waitcnt vmcnt(11)
    v_mfma_f32_32x32x16_bf16 v[32:47], v[196:199], v[96:99], v[32:47]
    v_mfma_f32_32x32x16_bf16 v[16:31], v[192:195], v[96:99], v[16:31]
    ds_read_b64_tr_b16 v[184:185], v4 offset:28160
    ds_read_b64_tr_b16 v[186:187], v4 offset:29184
    ds_read_b64_tr_b16 v[188:189], v5 offset:28160
    ds_read_b64_tr_b16 v[190:191], v5 offset:29184
    s_waitcnt vmcnt(10)
    v_mfma_f32_32x32x16_bf16 v[32:47], v[204:207], v[100:103], v[32:47]
    v_mfma_f32_32x32x16_bf16 v[16:31], v[200:203], v[100:103], v[16:31]
    s_waitcnt vmcnt(9)
    v_mfma_f32_32x32x16_bf16 v[32:47], v[212:215], v[104:107], v[32:47]
    v_mfma_f32_32x32x16_bf16 v[16:31], v[208:211], v[104:107], v[16:31]
    s_waitcnt vmcnt(8)
    v_mfma_f32_32x32x16_bf16 v[32:47], v[220:223], v[108:111], v[32:47]
    v_mfma_f32_32x32x16_bf16 v[16:31], v[216:219], v[108:111], v[16:31]
    s_waitcnt vmcnt(7)
    v_mfma_f32_32x32x16_bf16 v[32:47], v[52:55], v[112:115], v[32:47]
    v_mfma_f32_32x32x16_bf16 v[16:31], v[48:51], v[112:115], v[16:31]
    s_waitcnt vmcnt(6)
    v_mfma_f32_32x32x16_bf16 v[32:47], v[60:63], v[116:119], v[32:47]
    v_mfma_f32_32x32x16_bf16 v[16:31], v[56:59], v[116:119], v[16:31]
    s_waitcnt vmcnt(5)
    v_mfma_f32_32x32x16_bf16 v[32:47], v[68:71], v[120:123], v[32:47]
    v_mfma_f32_32x32x16_bf16 v[16:31], v[64:67], v[120:123], v[16:31]
    s_waitcnt vmcnt(4)
    v_mfma_f32_32x32x16_bf16 v[32:47], v[76:79], v[124:127], v[32:47]
    v_mfma_f32_32x32x16_bf16 v[16:31], v[72:75], v[124:127], v[16:31]
    s_waitcnt vmcnt(3)
    s_waitcnt lgkmcnt(12)
    v_mfma_f32_32x32x16_bf16 v[32:47], v[164:167], v[128:131], v[32:47]
    v_mfma_f32_32x32x16_bf16 v[16:31], v[160:163], v[128:131], v[16:31]
    s_waitcnt vmcnt(2)
    s_waitcnt lgkmcnt(8)
    v_mfma_f32_32x32x16_bf16 v[32:47], v[172:175], v[132:135], v[32:47]
    v_mfma_f32_32x32x16_bf16 v[16:31], v[168:171], v[132:135], v[16:31]
    s_waitcnt vmcnt(1)
    s_waitcnt lgkmcnt(4)
    v_mfma_f32_32x32x16_bf16 v[32:47], v[180:183], v[136:139], v[32:47]
    v_mfma_f32_32x32x16_bf16 v[16:31], v[176:179], v[136:139], v[16:31]
    s_waitcnt vmcnt(0)
    s_waitcnt lgkmcnt(0)
    v_mfma_f32_32x32x16_bf16 v[32:47], v[188:191], v[140:143], v[32:47]
    v_mfma_f32_32x32x16_bf16 v[16:31], v[184:187], v[140:143], v[16:31]
    s_mov_b32 s69, 0x400000
L_lc107:
    s_waitcnt lgkmcnt(0)
    v_readfirstlane_b32 s68, v11
    s_nop 0
    s_cmp_ge_u32 s68, 4
    s_cbranch_scc1 L_ld108
    ds_read_b32 v11, v10
    s_sub_u32 s69, s69, 1
    s_cbranch_scc0 L_lc107
L_ld108:
    s_nop 4
    ds_write_b128 v12, v[32:35] offset:0
    ds_write_b128 v12, v[36:39] offset:1024
    ds_write_b128 v12, v[40:43] offset:2048
    ds_write_b128 v12, v[44:47] offset:3072
    s_waitcnt lgkmcnt(0)
    v_mov_b32 v15, 1
    s_mov_b64 exec, 1
    ds_add_u32 v14, v15
    s_mov_b64 exec, -1
    ds_read_b32 v15, v14
    s_mov_b32 s69, 0x400000
L_lc109:
    s_waitcnt lgkmcnt(0)
    v_readfirstlane_b32 s68, v15
    s_nop 0
    s_cmp_ge_u32 s68, 2
    s_cbranch_scc1 L_ld110
    ds_read_b32 v15, v14
    s_sub_u32 s69, s69, 1
    s_cbranch_scc0 L_lc109
L_ld110:
    ds_read_b128 v[32:35], v13 offset:0
    ds_read_b128 v[36:39], v13 offset:1024
    ds_read_b128 v[40:43], v13 offset:2048
    ds_read_b128 v[44:47], v13 offset:3072
    s_waitcnt lgkmcnt(3)
    v_add_f32 v16, v16, v32
    v_add_f32 v17, v17, v33
    v_add_f32 v18, v18, v34
    v_add_f32 v19, v19, v35
    s_waitcnt lgkmcnt(2)
    v_add_f32 v20, v20, v36
    v_add_f32 v21, v21, v37
    v_add_f32 v22, v22, v38
    v_add_f32 v23, v23, v39
    s_waitcnt lgkmcnt(1)
    v_add_f32 v24, v24, v40
    v_add_f32 v25, v25, v41
    v_add_f32 v26, v26, v42
    v_add_f32 v27, v27, v43
    s_waitcnt lgkmcnt(0)
    v_add_f32 v28, v28, v44
    v_add_f32 v29, v29, v45
    v_add_f32 v30, v30, v46
    v_add_f32 v31, v31, v47
    v_fma_f32 v16, v16, v240, v224
    v_fma_f32 v17, v17, v241, v225
    v_fma_f32 v18, v18, v242, v226
    v_fma_f32 v19, v19, v243, v227
    v_fma_f32 v20, v20, v244, v228
    v_fma_f32 v21, v21, v245, v229
    v_fma_f32 v22, v22, v246, v230
    v_fma_f32 v23, v23, v247, v231
    v_fma_f32 v24, v24, v248, v232
    v_fma_f32 v25, v25, v249, v233
    v_fma_f32 v26, v26, v250, v234
    v_fma_f32 v27, v27, v251, v235
    v_fma_f32 v28, v28, v252, v236
    v_fma_f32 v29, v29, v253, v237
    v_fma_f32 v30, v30, v254, v238
    v_fma_f32 v31, v31, v255, v239
    v_cvt_pk_bf16_f32 v32, v16, v17
    v_cvt_pk_bf16_f32 v33, v18, v19
    v_cvt_pk_bf16_f32 v34, v20, v21
    v_cvt_pk_bf16_f32 v35, v22, v23
    v_cvt_pk_bf16_f32 v36, v24, v25
    v_cvt_pk_bf16_f32 v37, v26, v27
    v_cvt_pk_bf16_f32 v38, v28, v29
    v_cvt_pk_bf16_f32 v39, v30, v31
    v_permlane32_swap_b32 v32, v34
    v_permlane32_swap_b32 v33, v35
    v_permlane32_swap_b32 v36, v38
    v_permlane32_swap_b32 v37, v39
    buffer_store_dwordx4 v[32:35], v6, s[32:35], s61 offen
    buffer_store_dwordx4 v[36:39], v6, s[32:35], s61 offen offset:32
L_end:
    s_endpgm
L_code_end:
.fill 64, 4, 0xbf800000
    s_endpgm
.section .rodata,"a"
.p2align 6
.amdhsa_kernel recurrent_scan__softmax_full_mha__glu_gated_swiglu__prompt_kernel
  .amdhsa_next_free_vgpr 256
  .amdhsa_next_free_sgpr 102
  .amdhsa_accum_offset 256
  .amdhsa_group_segment_fixed_size 0
  .amdhsa_kernarg_size 80
  .amdhsa_user_sgpr_count 2
  .amdhsa_user_sgpr_kernarg_segment_ptr 1
  .amdhsa_system_sgpr_workgroup_id_x 1
.end_amdhsa_kernel
```
